```python
import torch

def _softmax(x, axis=-1):
    return torch.softmax(x, dim=axis)
def _gelu(x):
    return torch.nn.functional.gelu(x, approximate="tanh")
def _silu(x):
    return torch.nn.functional.silu(x)
def _sigmoid(x):
    return torch.sigmoid(x)
def _layernorm(x, axis=-1, eps=1e-5):
    m = x.mean(dim=axis, keepdim=True)
    v = x.var(dim=axis, keepdim=True, unbiased=False)
    return (x - m) / torch.sqrt(v + eps)
def _scatter_add(tgt, idx, src, axis=0):
    return tgt.clone().index_add_(axis, idx, src)
def _segment_sum(src, seg, n):
    out = torch.zeros((n,) + src.shape[1:], dtype=src.dtype)
    return out.index_add_(0, seg, src)
def _pad(x, pw):
    flat = tuple(v for pair in reversed(pw) for v in pair)
    return torch.nn.functional.pad(x, flat)

kernel_name = 'sequential_preLN__sliding_block__moe_arch_mod__prompt'

def setup_inputs():

    _w = (lambda a: (lambda t: t.to(torch.bfloat16) if t.is_floating_point() else t)(torch.as_tensor(a)))
    def _A_setup():
        B, S, D = 1, 2048, 512
        return {
            "x": _w((lambda *s: torch.randn(*s, dtype=torch.bfloat16) * 0.05)(B, S, D)),
            "wqkv": _w((lambda *s: torch.randn(*s, dtype=torch.bfloat16) * 0.05)(D, 3 * D)),
            "wo": _w((lambda *s: torch.randn(*s, dtype=torch.bfloat16) * 0.05)(D, D)),
        }
    _A_in = _A_setup()

    def _B_setup():
        B, S, D, F, C = 1, 2048, 512, 1376, 2
        return {
            "x": _w((lambda *s: torch.randn(*s, dtype=torch.bfloat16) * 0.05)(B, S, D)),
            "w_r": _w((lambda *s: torch.randn(*s, dtype=torch.bfloat16) * 0.05)(D)),
            "w_gate": _w((lambda *s: torch.randn(*s, dtype=torch.bfloat16) * 0.05)(D, F)),
            "w_up": _w((lambda *s: torch.randn(*s, dtype=torch.bfloat16) * 0.05)(D, F)),
            "w_down": _w((lambda *s: torch.randn(*s, dtype=torch.bfloat16) * 0.05)(F, D)),
        }
    _B_in = _B_setup()

    return {
        "A_x": _A_in["x"],
        "A_wqkv": _A_in["wqkv"],
        "A_wo": _A_in["wo"],
        "B_x": _B_in["x"],
        "B_w_r": _B_in["w_r"],
        "B_w_gate": _B_in["w_gate"],
        "B_w_up": _B_in["w_up"],
        "B_w_down": _B_in["w_down"],
    }

def reference(A_x, A_wqkv, A_wo, B_x, B_w_r, B_w_gate, B_w_up, B_w_down):
    def _A_ref(x, wqkv, wo):
        B, S, D = x.shape
        H = 32; Dh = D // H; W = 256
        qkv = (lambda x, *d: x.permute(*d))((x @ wqkv).reshape(B, S, 3, H, Dh), 2, 0, 3, 1, 4)
        q, k, v = qkv[0], qkv[1], qkv[2]
        scores = torch.einsum("bhqd,bhkd->bhqk", q, k) * (Dh ** -0.5)
        idx = torch.arange(S)
        mask = (idx[:, None] - idx[None, :] >= 0) & (idx[:, None] - idx[None, :] < W)
        scores = torch.where(mask[None, None], scores, -1e9)
        p = _softmax(scores, axis=-1)
        o = torch.einsum("bhqk,bhkd->bhqd", p, v)
        return (lambda x, *d: x.permute(*d))(o, 0, 2, 1, 3).reshape(B, S, D) @ wo

    def _B_ref(x, w_r, w_gate, w_up, w_down):
        B, S, D = x.shape
        C = 2
        r = x @ w_r
        idx = torch.argsort(-r, axis=-1)[:, :C]
        idx_e = (lambda x, n, axis: torch.repeat_interleave(x, n, dim=axis))(idx.reshape(B, C, 1), D, axis=2)
        x_sel = (lambda x, i, axis: torch.take_along_dim(x, i, dim=axis))(x, idx_e, axis=1)
        g = _silu(x_sel @ w_gate)
        u = x_sel @ w_up
        y = (g * u) @ w_down
        r_sel = _sigmoid((lambda x, i, axis: torch.take_along_dim(x, i, dim=axis))(r, idx, axis=1))
        y = y * r_sel.reshape(B, C, 1)
        b_off = (torch.arange(B) * S).reshape(B, 1)
        flat_idx = (idx + b_off).reshape(B * C)
        zero = (x * 0.0).reshape(B * S, D)
        upd = _scatter_add(zero, flat_idx, y.reshape(B * C, D), axis=0)
        return x + upd.reshape(B, S, D)

    x = A_x
    h = x + _A_ref(_layernorm(x, axis=-1), A_wqkv, A_wo)
    h2 = h + _B_ref(_layernorm(h, axis=-1), B_w_r, B_w_gate, B_w_up, B_w_down)
    return h2
```

```asm
; @launch kernel=k1_kernel grid=(256,1,1) block=(512,1,1) lds=163840
.amdgcn_target "amdgcn-amd-amdhsa--gfx950"
.text
.globl k1_kernel
.p2align 8
.type k1_kernel,@function
k1_kernel:
    s_cmp_ge_u32 s2, 256
    s_cbranch_scc1 K3_END
    s_load_dwordx4 s[4:7], s[0:1], 0
    s_load_dwordx2 s[8:9], s[0:1], 80
    v_lshrrev_b32 v1, 6, v0
    v_and_b32 v2, 63, v0
    v_readfirstlane_b32 s33, v1
    s_and_b32 s20, s2, 7
    s_lshr_b32 s21, s2, 3
    s_lshr_b32 s22, s20, 1
    s_lshl_b32 s22, s22, 3
    s_lshr_b32 s29, s21, 2
    s_add_u32 s22, s22, s29
    s_and_b32 s23, s20, 1
    s_lshl_b32 s23, s23, 2
    s_and_b32 s24, s21, 3
    s_add_u32 s23, s23, s24
    s_lshl_b32 s24, s24, 1
    s_add_u32 s29, s29, s24
    s_and_b32 s25, s33, 3
    s_cmp_lt_u32 s33, 4
    s_cbranch_scc1 K1_COMPUTE
    s_setprio 3
    v_lshrrev_b32 v13, 3, v2
    v_and_b32 v14, 7, v2
    v_lshrrev_b32 v12, 4, v2
    v_xor_b32 v11, v14, v12
    v_lshlrev_b32 v11, 4, v11
    v_lshl_add_u32 v10, v13, 10, v11
    s_lshl_b32 s27, s22, 16
    s_lshl_b32 s28, s25, 14
    s_add_u32 s27, s27, s28
    v_add_u32 v10, s27, v10
    v_xor_b32 v11, 64, v10
    v_add_u32 v11, 8192, v11
    v_and_b32 v12, 1, v12
    v_lshlrev_b32 v12, 2, v12
    v_xor_b32 v12, v12, v14
    v_lshlrev_b32 v12, 4, v12
    v_mul_u32_u24 v13, 3072, v13
    s_mul_i32 s27, s25, 24576
    s_lshl_b32 s28, s23, 7
    s_add_u32 s27, s27, s28
    v_add3_u32 v12, v12, v13, s27
    s_lshl_b32 s30, s25, 10
    s_add_u32 s30, s30, 65536
    s_lshl_b32 s31, s25, 11
    s_waitcnt lgkmcnt(0)
    s_mov_b32 s12, s4
    s_mov_b32 s13, s5
    s_mov_b32 s14, 0x00200000
    s_mov_b32 s15, 0x00020000
    s_mov_b32 s16, s6
    s_mov_b32 s17, s7
    s_mov_b32 s18, 0x00180000
    s_mov_b32 s19, 0x00020000
    s_add_u32 s34, s29, 0
    s_and_b32 s34, s34, 7
    s_lshl_b32 s35, s34, 7
    s_mul_i32 s34, s34, 196608
    s_add_u32 m0, s31, 0
    s_nop 0
    buffer_load_dwordx4 v10, s[12:15], s35 offen lds
    s_add_u32 m0, s31, 1024
    s_nop 0
    buffer_load_dwordx4 v11, s[12:15], s35 offen lds
    s_add_u32 m0, s30, 0
    s_nop 0
    buffer_load_dwordx4 v12, s[16:19], s34 offen offset:0 lds
    s_add_u32 m0, s30, 3072
    s_nop 0
    buffer_load_dwordx4 v12, s[16:19], s34 offen offset:1024 lds
    s_add_u32 s34, s34, 98304
    s_add_u32 m0, s30, 8192
    s_nop 0
    buffer_load_dwordx4 v12, s[16:19], s34 offen offset:0 lds
    s_add_u32 m0, s30, 11264
    s_nop 0
    buffer_load_dwordx4 v12, s[16:19], s34 offen offset:1024 lds
    s_add_u32 s34, s29, 1
    s_and_b32 s34, s34, 7
    s_lshl_b32 s35, s34, 7
    s_mul_i32 s34, s34, 196608
    s_add_u32 m0, s31, 8192
    s_nop 0
    buffer_load_dwordx4 v10, s[12:15], s35 offen lds
    s_add_u32 m0, s31, 9216
    s_nop 0
    buffer_load_dwordx4 v11, s[12:15], s35 offen lds
    s_add_u32 m0, s30, 16384
    s_nop 0
    buffer_load_dwordx4 v12, s[16:19], s34 offen offset:0 lds
    s_add_u32 m0, s30, 19456
    s_nop 0
    buffer_load_dwordx4 v12, s[16:19], s34 offen offset:1024 lds
    s_and_b32 s36, s25, 1
    s_lshr_b32 s37, s25, 1
    s_mov_b32 s38, 106496
    v_lshrrev_b32 v3, 5, v2
    v_and_b32 v4, 31, v2
    v_bfe_u32 v8, v2, 2, 2
    v_lshl_add_u32 v8, v3, 3, v8
    v_and_b32 v7, 3, v2
    v_lshlrev_b32 v7, 3, v7
    v_bfe_u32 v9, v2, 4, 1
    v_lshl_add_u32 v7, v9, 5, v7
    v_bfe_u32 v5, v2, 3, 1
    v_lshl_add_u32 v7, v5, 6, v7
    v_lshl_add_u32 v7, v8, 7, v7
    s_lshl_b32 s27, s37, 6
    s_lshl_b32 s28, s36, 11
    s_or_b32 s27, s27, s28
    v_xor_b32 v28, s27, v7
    v_add_u32 v28, 65536, v28
    v_mov_b32 v24, 0
    v_mov_b32 v25, 0
    v_mov_b32 v26, 0
    v_mov_b32 v15, 0x3f803f80
    v_lshlrev_b32 v27, 2, v4
    v_add_u32 v27, 106496, v27
    s_mul_i32 s28, s25, 384
    v_add_u32 v30, s28, v27
    s_load_dwordx2 s[56:57], s[0:1], 16
    s_lshl_b32 s27, s21, 14
    s_lshl_b32 s28, s25, 13
    s_add_u32 s27, s27, s28
    s_lshr_b32 s28, s25, 1
    s_lshl_b32 s28, s28, 28
    s_add_u32 s27, s27, s28
    v_lshlrev_b32 v58, 7, v2
    v_add_u32 v58, s27, v58
    s_lshl_b32 s28, s25, 6
    v_add_u32 v20, s28, v2
    v_cmp_le_u32 vcc, 96, v20
    s_nop 1
    v_cndmask_b32 v21, 0, 1, vcc
    v_mul_u32_u24 v21, 384, v21
    v_lshlrev_b32 v20, 2, v20
    v_add3_u32 v60, v21, v20, s38
    v_add_u32 v61, 106496, v20
    s_waitcnt lgkmcnt(0)
    s_mov_b32 s60, s56
    s_mov_b32 s61, s57
    s_mov_b32 s62, 0x00080000
    s_mov_b32 s63, 0x00020000
    s_waitcnt vmcnt(6)
    s_barrier
    ds_read_b64_tr_b16 v[32:33], v28 offset:0
    ds_read_b64_tr_b16 v[34:35], v28 offset:512
    ds_read_b64_tr_b16 v[36:37], v28 offset:4096
    ds_read_b64_tr_b16 v[38:39], v28 offset:4608
    s_add_u32 s34, s34, 98304
    s_add_u32 m0, s30, 24576
    s_nop 0
    buffer_load_dwordx4 v12, s[16:19], s34 offen offset:0 lds
    s_add_u32 m0, s30, 27648
    s_nop 0
    buffer_load_dwordx4 v12, s[16:19], s34 offen offset:1024 lds
    s_waitcnt vmcnt(6)
    s_barrier
    ds_read_b64_tr_b16 v[40:41], v28 offset:8192
    ds_read_b64_tr_b16 v[42:43], v28 offset:8704
    ds_read_b64_tr_b16 v[44:45], v28 offset:12288
    ds_read_b64_tr_b16 v[46:47], v28 offset:12800
    s_add_u32 s34, s29, 2
    s_and_b32 s34, s34, 7
    s_lshl_b32 s35, s34, 7
    s_mul_i32 s34, s34, 196608
    s_add_u32 m0, s31, 16384
    s_nop 0
    buffer_load_dwordx4 v10, s[12:15], s35 offen lds
    s_add_u32 m0, s31, 17408
    s_nop 0
    buffer_load_dwordx4 v11, s[12:15], s35 offen lds
    s_add_u32 m0, s30, 32768
    s_nop 0
    buffer_load_dwordx4 v12, s[16:19], s34 offen offset:0 lds
    s_add_u32 m0, s30, 35840
    s_nop 0
    buffer_load_dwordx4 v12, s[16:19], s34 offen offset:1024 lds
    s_waitcnt lgkmcnt(4)
    v_dot2c_f32_bf16 v24, v32, v15
    v_dot2c_f32_bf16 v25, v36, v15
    v_dot2c_f32_bf16 v24, v33, v15
    v_dot2c_f32_bf16 v25, v37, v15
    v_dot2c_f32_bf16 v24, v34, v15
    v_dot2c_f32_bf16 v25, v38, v15
    v_dot2c_f32_bf16 v24, v35, v15
    v_dot2c_f32_bf16 v25, v39, v15
    s_waitcnt vmcnt(6)
    s_barrier
    ds_read_b64_tr_b16 v[32:33], v28 offset:16384
    ds_read_b64_tr_b16 v[34:35], v28 offset:16896
    ds_read_b64_tr_b16 v[36:37], v28 offset:20480
    ds_read_b64_tr_b16 v[38:39], v28 offset:20992
    s_add_u32 s34, s34, 98304
    s_add_u32 m0, s30, 0
    s_nop 0
    buffer_load_dwordx4 v12, s[16:19], s34 offen offset:0 lds
    s_add_u32 m0, s30, 3072
    s_nop 0
    buffer_load_dwordx4 v12, s[16:19], s34 offen offset:1024 lds
    s_waitcnt lgkmcnt(4)
    v_dot2c_f32_bf16 v24, v40, v15
    v_dot2c_f32_bf16 v25, v44, v15
    v_dot2c_f32_bf16 v24, v41, v15
    v_dot2c_f32_bf16 v25, v45, v15
    v_dot2c_f32_bf16 v24, v42, v15
    v_dot2c_f32_bf16 v25, v46, v15
    v_dot2c_f32_bf16 v24, v43, v15
    v_dot2c_f32_bf16 v25, v47, v15
    s_waitcnt vmcnt(6)
    s_barrier
    ds_read_b64_tr_b16 v[40:41], v28 offset:24576
    ds_read_b64_tr_b16 v[42:43], v28 offset:25088
    ds_read_b64_tr_b16 v[44:45], v28 offset:28672
    ds_read_b64_tr_b16 v[46:47], v28 offset:29184
    s_add_u32 s34, s29, 3
    s_and_b32 s34, s34, 7
    s_lshl_b32 s35, s34, 7
    s_mul_i32 s34, s34, 196608
    s_add_u32 m0, s31, 24576
    s_nop 0
    buffer_load_dwordx4 v10, s[12:15], s35 offen lds
    s_add_u32 m0, s31, 25600
    s_nop 0
    buffer_load_dwordx4 v11, s[12:15], s35 offen lds
    s_add_u32 m0, s30, 8192
    s_nop 0
    buffer_load_dwordx4 v12, s[16:19], s34 offen offset:0 lds
    s_add_u32 m0, s30, 11264
    s_nop 0
    buffer_load_dwordx4 v12, s[16:19], s34 offen offset:1024 lds
    s_waitcnt lgkmcnt(4)
    v_dot2c_f32_bf16 v24, v32, v15
    v_dot2c_f32_bf16 v25, v36, v15
    v_dot2c_f32_bf16 v24, v33, v15
    v_dot2c_f32_bf16 v25, v37, v15
    v_dot2c_f32_bf16 v24, v34, v15
    v_dot2c_f32_bf16 v25, v38, v15
    v_dot2c_f32_bf16 v24, v35, v15
    v_dot2c_f32_bf16 v25, v39, v15
    s_waitcnt vmcnt(6)
    s_barrier
    ds_read_b64_tr_b16 v[32:33], v28 offset:32768
    ds_read_b64_tr_b16 v[34:35], v28 offset:33280
    ds_read_b64_tr_b16 v[36:37], v28 offset:36864
    ds_read_b64_tr_b16 v[38:39], v28 offset:37376
    s_add_u32 s34, s34, 98304
    s_add_u32 m0, s30, 16384
    s_nop 0
    buffer_load_dwordx4 v12, s[16:19], s34 offen offset:0 lds
    s_add_u32 m0, s30, 19456
    s_nop 0
    buffer_load_dwordx4 v12, s[16:19], s34 offen offset:1024 lds
    s_waitcnt lgkmcnt(4)
    v_dot2c_f32_bf16 v24, v40, v15
    v_dot2c_f32_bf16 v25, v44, v15
    v_dot2c_f32_bf16 v24, v41, v15
    v_dot2c_f32_bf16 v25, v45, v15
    v_dot2c_f32_bf16 v24, v42, v15
    v_dot2c_f32_bf16 v25, v46, v15
    v_dot2c_f32_bf16 v24, v43, v15
    v_dot2c_f32_bf16 v25, v47, v15
    s_waitcnt vmcnt(6)
    s_barrier
    ds_read_b64_tr_b16 v[40:41], v28 offset:0
    ds_read_b64_tr_b16 v[42:43], v28 offset:512
    ds_read_b64_tr_b16 v[44:45], v28 offset:4096
    ds_read_b64_tr_b16 v[46:47], v28 offset:4608
    s_add_u32 s34, s29, 4
    s_and_b32 s34, s34, 7
    s_lshl_b32 s35, s34, 7
    s_mul_i32 s34, s34, 196608
    s_add_u32 m0, s31, 32768
    s_nop 0
    buffer_load_dwordx4 v10, s[12:15], s35 offen lds
    s_add_u32 m0, s31, 33792
    s_nop 0
    buffer_load_dwordx4 v11, s[12:15], s35 offen lds
    s_add_u32 m0, s30, 24576
    s_nop 0
    buffer_load_dwordx4 v12, s[16:19], s34 offen offset:0 lds
    s_add_u32 m0, s30, 27648
    s_nop 0
    buffer_load_dwordx4 v12, s[16:19], s34 offen offset:1024 lds
    s_waitcnt lgkmcnt(4)
    v_dot2c_f32_bf16 v24, v32, v15
    v_dot2c_f32_bf16 v25, v36, v15
    v_dot2c_f32_bf16 v24, v33, v15
    v_dot2c_f32_bf16 v25, v37, v15
    v_dot2c_f32_bf16 v24, v34, v15
    v_dot2c_f32_bf16 v25, v38, v15
    v_dot2c_f32_bf16 v24, v35, v15
    v_dot2c_f32_bf16 v25, v39, v15
    s_waitcnt vmcnt(6)
    s_barrier
    ds_read_b64_tr_b16 v[32:33], v28 offset:8192
    ds_read_b64_tr_b16 v[34:35], v28 offset:8704
    ds_read_b64_tr_b16 v[36:37], v28 offset:12288
    ds_read_b64_tr_b16 v[38:39], v28 offset:12800
    s_add_u32 s34, s34, 98304
    s_add_u32 m0, s30, 32768
    s_nop 0
    buffer_load_dwordx4 v12, s[16:19], s34 offen offset:0 lds
    s_add_u32 m0, s30, 35840
    s_nop 0
    buffer_load_dwordx4 v12, s[16:19], s34 offen offset:1024 lds
    s_waitcnt lgkmcnt(4)
    v_dot2c_f32_bf16 v24, v40, v15
    v_dot2c_f32_bf16 v25, v44, v15
    v_dot2c_f32_bf16 v24, v41, v15
    v_dot2c_f32_bf16 v25, v45, v15
    v_dot2c_f32_bf16 v24, v42, v15
    v_dot2c_f32_bf16 v25, v46, v15
    v_dot2c_f32_bf16 v24, v43, v15
    v_dot2c_f32_bf16 v25, v47, v15
    s_waitcnt vmcnt(6)
    s_barrier
    ds_read_b64_tr_b16 v[40:41], v28 offset:16384
    ds_read_b64_tr_b16 v[42:43], v28 offset:16896
    ds_read_b64_tr_b16 v[44:45], v28 offset:20480
    ds_read_b64_tr_b16 v[46:47], v28 offset:20992
    s_add_u32 s34, s29, 5
    s_and_b32 s34, s34, 7
    s_lshl_b32 s35, s34, 7
    s_mul_i32 s34, s34, 196608
    s_add_u32 m0, s31, 40960
    s_nop 0
    buffer_load_dwordx4 v10, s[12:15], s35 offen lds
    s_add_u32 m0, s31, 41984
    s_nop 0
    buffer_load_dwordx4 v11, s[12:15], s35 offen lds
    s_add_u32 m0, s30, 0
    s_nop 0
    buffer_load_dwordx4 v12, s[16:19], s34 offen offset:0 lds
    s_add_u32 m0, s30, 3072
    s_nop 0
    buffer_load_dwordx4 v12, s[16:19], s34 offen offset:1024 lds
    s_waitcnt lgkmcnt(4)
    v_dot2c_f32_bf16 v24, v32, v15
    v_dot2c_f32_bf16 v25, v36, v15
    v_dot2c_f32_bf16 v24, v33, v15
    v_dot2c_f32_bf16 v25, v37, v15
    v_dot2c_f32_bf16 v24, v34, v15
    v_dot2c_f32_bf16 v25, v38, v15
    v_dot2c_f32_bf16 v24, v35, v15
    v_dot2c_f32_bf16 v25, v39, v15
    s_waitcnt vmcnt(6)
    s_barrier
    ds_read_b64_tr_b16 v[32:33], v28 offset:24576
    ds_read_b64_tr_b16 v[34:35], v28 offset:25088
    ds_read_b64_tr_b16 v[36:37], v28 offset:28672
    ds_read_b64_tr_b16 v[38:39], v28 offset:29184
    s_add_u32 s34, s34, 98304
    s_add_u32 m0, s30, 8192
    s_nop 0
    buffer_load_dwordx4 v12, s[16:19], s34 offen offset:0 lds
    s_add_u32 m0, s30, 11264
    s_nop 0
    buffer_load_dwordx4 v12, s[16:19], s34 offen offset:1024 lds
    s_waitcnt lgkmcnt(4)
    v_dot2c_f32_bf16 v24, v40, v15
    v_dot2c_f32_bf16 v25, v44, v15
    v_dot2c_f32_bf16 v24, v41, v15
    v_dot2c_f32_bf16 v25, v45, v15
    v_dot2c_f32_bf16 v24, v42, v15
    v_dot2c_f32_bf16 v25, v46, v15
    v_dot2c_f32_bf16 v24, v43, v15
    v_dot2c_f32_bf16 v25, v47, v15
    s_waitcnt vmcnt(6)
    s_barrier
    ds_read_b64_tr_b16 v[40:41], v28 offset:32768
    ds_read_b64_tr_b16 v[42:43], v28 offset:33280
    ds_read_b64_tr_b16 v[44:45], v28 offset:36864
    ds_read_b64_tr_b16 v[46:47], v28 offset:37376
    s_add_u32 s34, s29, 6
    s_and_b32 s34, s34, 7
    s_lshl_b32 s35, s34, 7
    s_mul_i32 s34, s34, 196608
    s_add_u32 m0, s31, 49152
    s_nop 0
    buffer_load_dwordx4 v10, s[12:15], s35 offen lds
    s_add_u32 m0, s31, 50176
    s_nop 0
    buffer_load_dwordx4 v11, s[12:15], s35 offen lds
    s_add_u32 m0, s30, 16384
    s_nop 0
    buffer_load_dwordx4 v12, s[16:19], s34 offen offset:0 lds
    s_add_u32 m0, s30, 19456
    s_nop 0
    buffer_load_dwordx4 v12, s[16:19], s34 offen offset:1024 lds
    s_waitcnt lgkmcnt(4)
    v_dot2c_f32_bf16 v24, v32, v15
    v_dot2c_f32_bf16 v25, v36, v15
    v_dot2c_f32_bf16 v24, v33, v15
    v_dot2c_f32_bf16 v25, v37, v15
    v_dot2c_f32_bf16 v24, v34, v15
    v_dot2c_f32_bf16 v25, v38, v15
    v_dot2c_f32_bf16 v24, v35, v15
    v_dot2c_f32_bf16 v25, v39, v15
    s_waitcnt vmcnt(6)
    s_barrier
    ds_read_b64_tr_b16 v[32:33], v28 offset:0
    ds_read_b64_tr_b16 v[34:35], v28 offset:512
    ds_read_b64_tr_b16 v[36:37], v28 offset:4096
    ds_read_b64_tr_b16 v[38:39], v28 offset:4608
    s_add_u32 s34, s34, 98304
    s_add_u32 m0, s30, 24576
    s_nop 0
    buffer_load_dwordx4 v12, s[16:19], s34 offen offset:0 lds
    s_add_u32 m0, s30, 27648
    s_nop 0
    buffer_load_dwordx4 v12, s[16:19], s34 offen offset:1024 lds
    s_waitcnt lgkmcnt(4)
    v_dot2c_f32_bf16 v24, v40, v15
    v_dot2c_f32_bf16 v25, v44, v15
    v_dot2c_f32_bf16 v24, v41, v15
    v_dot2c_f32_bf16 v25, v45, v15
    v_dot2c_f32_bf16 v24, v42, v15
    v_dot2c_f32_bf16 v25, v46, v15
    v_dot2c_f32_bf16 v24, v43, v15
    v_dot2c_f32_bf16 v25, v47, v15
    s_waitcnt vmcnt(6)
    s_barrier
    ds_read_b64_tr_b16 v[40:41], v28 offset:8192
    ds_read_b64_tr_b16 v[42:43], v28 offset:8704
    ds_read_b64_tr_b16 v[44:45], v28 offset:12288
    ds_read_b64_tr_b16 v[46:47], v28 offset:12800
    s_add_u32 s34, s29, 7
    s_and_b32 s34, s34, 7
    s_lshl_b32 s35, s34, 7
    s_mul_i32 s34, s34, 196608
    s_add_u32 m0, s31, 57344
    s_nop 0
    buffer_load_dwordx4 v10, s[12:15], s35 offen lds
    s_add_u32 m0, s31, 58368
    s_nop 0
    buffer_load_dwordx4 v11, s[12:15], s35 offen lds
    s_add_u32 m0, s30, 32768
    s_nop 0
    buffer_load_dwordx4 v12, s[16:19], s34 offen offset:0 lds
    s_add_u32 m0, s30, 35840
    s_nop 0
    buffer_load_dwordx4 v12, s[16:19], s34 offen offset:1024 lds
    s_waitcnt lgkmcnt(4)
    v_dot2c_f32_bf16 v24, v32, v15
    v_dot2c_f32_bf16 v25, v36, v15
    v_dot2c_f32_bf16 v24, v33, v15
    v_dot2c_f32_bf16 v25, v37, v15
    v_dot2c_f32_bf16 v24, v34, v15
    v_dot2c_f32_bf16 v25, v38, v15
    v_dot2c_f32_bf16 v24, v35, v15
    v_dot2c_f32_bf16 v25, v39, v15
    s_waitcnt vmcnt(6)
    s_barrier
    ds_read_b64_tr_b16 v[32:33], v28 offset:16384
    ds_read_b64_tr_b16 v[34:35], v28 offset:16896
    ds_read_b64_tr_b16 v[36:37], v28 offset:20480
    ds_read_b64_tr_b16 v[38:39], v28 offset:20992
    s_add_u32 s34, s34, 98304
    s_add_u32 m0, s30, 0
    s_nop 0
    buffer_load_dwordx4 v12, s[16:19], s34 offen offset:0 lds
    s_add_u32 m0, s30, 3072
    s_nop 0
    buffer_load_dwordx4 v12, s[16:19], s34 offen offset:1024 lds
    s_waitcnt lgkmcnt(4)
    v_dot2c_f32_bf16 v24, v40, v15
    v_dot2c_f32_bf16 v25, v44, v15
    v_dot2c_f32_bf16 v24, v41, v15
    v_dot2c_f32_bf16 v25, v45, v15
    v_dot2c_f32_bf16 v24, v42, v15
    v_dot2c_f32_bf16 v25, v46, v15
    v_dot2c_f32_bf16 v24, v43, v15
    v_dot2c_f32_bf16 v25, v47, v15
    s_waitcnt vmcnt(6)
    s_barrier
    ds_read_b64_tr_b16 v[40:41], v28 offset:24576
    ds_read_b64_tr_b16 v[42:43], v28 offset:25088
    ds_read_b64_tr_b16 v[44:45], v28 offset:28672
    ds_read_b64_tr_b16 v[46:47], v28 offset:29184
    s_add_u32 s34, s29, 0
    s_and_b32 s34, s34, 7
    s_mul_i32 s34, s34, 196608
    s_add_u32 m0, s30, 6144
    s_nop 0
    buffer_load_dwordx4 v12, s[16:19], s34 offen offset:2048 lds
    s_add_u32 s34, s34, 98304
    s_add_u32 m0, s30, 10240
    s_nop 0
    buffer_load_dwordx4 v12, s[16:19], s34 offen offset:2048 lds
    s_waitcnt lgkmcnt(4)
    v_dot2c_f32_bf16 v24, v32, v15
    v_dot2c_f32_bf16 v25, v36, v15
    v_dot2c_f32_bf16 v24, v33, v15
    v_dot2c_f32_bf16 v25, v37, v15
    v_dot2c_f32_bf16 v24, v34, v15
    v_dot2c_f32_bf16 v25, v38, v15
    v_dot2c_f32_bf16 v24, v35, v15
    v_dot2c_f32_bf16 v25, v39, v15
    s_waitcnt vmcnt(4)
    s_barrier
    ds_read_b64_tr_b16 v[32:33], v28 offset:32768
    ds_read_b64_tr_b16 v[34:35], v28 offset:33280
    ds_read_b64_tr_b16 v[36:37], v28 offset:36864
    ds_read_b64_tr_b16 v[38:39], v28 offset:37376
    s_add_u32 s34, s29, 1
    s_and_b32 s34, s34, 7
    s_mul_i32 s34, s34, 196608
    s_add_u32 m0, s30, 14336
    s_nop 0
    buffer_load_dwordx4 v12, s[16:19], s34 offen offset:2048 lds
    s_add_u32 s34, s34, 98304
    s_add_u32 m0, s30, 18432
    s_nop 0
    buffer_load_dwordx4 v12, s[16:19], s34 offen offset:2048 lds
    s_waitcnt lgkmcnt(4)
    v_dot2c_f32_bf16 v24, v40, v15
    v_dot2c_f32_bf16 v25, v44, v15
    v_dot2c_f32_bf16 v24, v41, v15
    v_dot2c_f32_bf16 v25, v45, v15
    v_dot2c_f32_bf16 v24, v42, v15
    v_dot2c_f32_bf16 v25, v46, v15
    v_dot2c_f32_bf16 v24, v43, v15
    v_dot2c_f32_bf16 v25, v47, v15
    s_waitcnt vmcnt(4)
    s_barrier
    ds_read_b64_tr_b16 v[40:41], v28 offset:0
    ds_read_b64_tr_b16 v[42:43], v28 offset:512
    ds_read_b64_tr_b16 v[44:45], v28 offset:4096
    ds_read_b64_tr_b16 v[46:47], v28 offset:4608
    s_add_u32 s34, s29, 2
    s_and_b32 s34, s34, 7
    s_mul_i32 s34, s34, 196608
    s_add_u32 m0, s30, 22528
    s_nop 0
    buffer_load_dwordx4 v12, s[16:19], s34 offen offset:2048 lds
    s_add_u32 s34, s34, 98304
    s_add_u32 m0, s30, 26624
    s_nop 0
    buffer_load_dwordx4 v12, s[16:19], s34 offen offset:2048 lds
    s_waitcnt lgkmcnt(4)
    v_dot2c_f32_bf16 v24, v32, v15
    v_dot2c_f32_bf16 v25, v36, v15
    v_dot2c_f32_bf16 v24, v33, v15
    v_dot2c_f32_bf16 v25, v37, v15
    v_dot2c_f32_bf16 v24, v34, v15
    v_dot2c_f32_bf16 v25, v38, v15
    v_dot2c_f32_bf16 v24, v35, v15
    v_dot2c_f32_bf16 v25, v39, v15
    s_waitcnt lgkmcnt(0)
    v_dot2c_f32_bf16 v24, v40, v15
    v_dot2c_f32_bf16 v25, v44, v15
    v_dot2c_f32_bf16 v24, v41, v15
    v_dot2c_f32_bf16 v25, v45, v15
    v_dot2c_f32_bf16 v24, v42, v15
    v_dot2c_f32_bf16 v25, v46, v15
    v_dot2c_f32_bf16 v24, v43, v15
    v_dot2c_f32_bf16 v25, v47, v15
    s_nop 1
    v_mov_b32 v20, v24
    v_mov_b32 v21, v25
    s_nop 0
    v_permlane32_swap_b32 v24, v20
    v_permlane32_swap_b32 v25, v21
    v_add_f32 v24, v24, v20
    ds_write_b32 v30, v24 offset:1024
    v_add_f32 v25, v25, v21
    ds_write_b32 v30, v25 offset:1152
    s_waitcnt lgkmcnt(0)
    s_barrier
    ds_read_b32 v22, v60 offset:1024
    ds_read_b32 v23, v60 offset:1408
    s_waitcnt lgkmcnt(0)
    v_add_f32 v22, v22, v23
    ds_write_b32 v61, v22
    s_waitcnt lgkmcnt(0)
    s_barrier
    s_waitcnt vmcnt(4)
    s_barrier
    ds_read_b64_tr_b16 v[32:33], v28 offset:8192
    ds_read_b64_tr_b16 v[34:35], v28 offset:8704
    ds_read_b64_tr_b16 v[36:37], v28 offset:12288
    ds_read_b64_tr_b16 v[38:39], v28 offset:12800
    s_add_u32 s34, s29, 3
    s_and_b32 s34, s34, 7
    s_mul_i32 s34, s34, 196608
    s_add_u32 m0, s30, 30720
    s_nop 0
    buffer_load_dwordx4 v12, s[16:19], s34 offen offset:2048 lds
    s_add_u32 s34, s34, 98304
    s_add_u32 m0, s30, 34816
    s_nop 0
    buffer_load_dwordx4 v12, s[16:19], s34 offen offset:2048 lds
    s_waitcnt vmcnt(4)
    s_barrier
    ds_read_b64_tr_b16 v[40:41], v28 offset:16384
    ds_read_b64_tr_b16 v[42:43], v28 offset:16896
    ds_read_b64_tr_b16 v[44:45], v28 offset:20480
    ds_read_b64_tr_b16 v[46:47], v28 offset:20992
    s_add_u32 s34, s29, 4
    s_and_b32 s34, s34, 7
    s_mul_i32 s34, s34, 196608
    s_add_u32 m0, s30, -2048
    s_nop 0
    buffer_load_dwordx4 v12, s[16:19], s34 offen offset:2048 lds
    s_add_u32 s34, s34, 98304
    s_add_u32 m0, s30, 2048
    s_nop 0
    buffer_load_dwordx4 v12, s[16:19], s34 offen offset:2048 lds
    s_waitcnt lgkmcnt(4)
    v_dot2c_f32_bf16 v26, v32, v15
    v_dot2c_f32_bf16 v26, v36, v15
    v_dot2c_f32_bf16 v26, v33, v15
    v_dot2c_f32_bf16 v26, v37, v15
    v_dot2c_f32_bf16 v26, v34, v15
    v_dot2c_f32_bf16 v26, v38, v15
    v_dot2c_f32_bf16 v26, v35, v15
    v_dot2c_f32_bf16 v26, v39, v15
    s_waitcnt vmcnt(4)
    s_barrier
    ds_read_b64_tr_b16 v[32:33], v28 offset:24576
    ds_read_b64_tr_b16 v[34:35], v28 offset:25088
    ds_read_b64_tr_b16 v[36:37], v28 offset:28672
    ds_read_b64_tr_b16 v[38:39], v28 offset:29184
    s_add_u32 s34, s29, 5
    s_and_b32 s34, s34, 7
    s_mul_i32 s34, s34, 196608
    s_add_u32 m0, s30, 6144
    s_nop 0
    buffer_load_dwordx4 v12, s[16:19], s34 offen offset:2048 lds
    s_add_u32 s34, s34, 98304
    s_add_u32 m0, s30, 10240
    s_nop 0
    buffer_load_dwordx4 v12, s[16:19], s34 offen offset:2048 lds
    s_waitcnt lgkmcnt(4)
    v_dot2c_f32_bf16 v26, v40, v15
    v_dot2c_f32_bf16 v26, v44, v15
    v_dot2c_f32_bf16 v26, v41, v15
    v_dot2c_f32_bf16 v26, v45, v15
    v_dot2c_f32_bf16 v26, v42, v15
    v_dot2c_f32_bf16 v26, v46, v15
    v_dot2c_f32_bf16 v26, v43, v15
    v_dot2c_f32_bf16 v26, v47, v15
    s_waitcnt vmcnt(4)
    s_barrier
    ds_read_b64_tr_b16 v[40:41], v28 offset:32768
    ds_read_b64_tr_b16 v[42:43], v28 offset:33280
    ds_read_b64_tr_b16 v[44:45], v28 offset:36864
    ds_read_b64_tr_b16 v[46:47], v28 offset:37376
    s_add_u32 s34, s29, 6
    s_and_b32 s34, s34, 7
    s_mul_i32 s34, s34, 196608
    s_add_u32 m0, s30, 14336
    s_nop 0
    buffer_load_dwordx4 v12, s[16:19], s34 offen offset:2048 lds
    s_add_u32 s34, s34, 98304
    s_add_u32 m0, s30, 18432
    s_nop 0
    buffer_load_dwordx4 v12, s[16:19], s34 offen offset:2048 lds
    s_waitcnt lgkmcnt(4)
    v_dot2c_f32_bf16 v26, v32, v15
    v_dot2c_f32_bf16 v26, v36, v15
    v_dot2c_f32_bf16 v26, v33, v15
    v_dot2c_f32_bf16 v26, v37, v15
    v_dot2c_f32_bf16 v26, v34, v15
    v_dot2c_f32_bf16 v26, v38, v15
    v_dot2c_f32_bf16 v26, v35, v15
    v_dot2c_f32_bf16 v26, v39, v15
    s_waitcnt vmcnt(4)
    s_barrier
    ds_read_b64_tr_b16 v[32:33], v28 offset:0
    ds_read_b64_tr_b16 v[34:35], v28 offset:512
    ds_read_b64_tr_b16 v[36:37], v28 offset:4096
    ds_read_b64_tr_b16 v[38:39], v28 offset:4608
    s_add_u32 s34, s29, 7
    s_and_b32 s34, s34, 7
    s_mul_i32 s34, s34, 196608
    s_add_u32 m0, s30, 22528
    s_nop 0
    buffer_load_dwordx4 v12, s[16:19], s34 offen offset:2048 lds
    s_add_u32 s34, s34, 98304
    s_add_u32 m0, s30, 26624
    s_nop 0
    buffer_load_dwordx4 v12, s[16:19], s34 offen offset:2048 lds
    s_waitcnt lgkmcnt(4)
    v_dot2c_f32_bf16 v26, v40, v15
    v_dot2c_f32_bf16 v26, v44, v15
    v_dot2c_f32_bf16 v26, v41, v15
    v_dot2c_f32_bf16 v26, v45, v15
    v_dot2c_f32_bf16 v26, v42, v15
    v_dot2c_f32_bf16 v26, v46, v15
    v_dot2c_f32_bf16 v26, v43, v15
    v_dot2c_f32_bf16 v26, v47, v15
    s_waitcnt vmcnt(4)
    s_barrier
    ds_read_b64_tr_b16 v[40:41], v28 offset:8192
    ds_read_b64_tr_b16 v[42:43], v28 offset:8704
    ds_read_b64_tr_b16 v[44:45], v28 offset:12288
    ds_read_b64_tr_b16 v[46:47], v28 offset:12800
    s_waitcnt lgkmcnt(4)
    v_dot2c_f32_bf16 v26, v32, v15
    v_dot2c_f32_bf16 v26, v36, v15
    v_dot2c_f32_bf16 v26, v33, v15
    v_dot2c_f32_bf16 v26, v37, v15
    v_dot2c_f32_bf16 v26, v34, v15
    v_dot2c_f32_bf16 v26, v38, v15
    v_dot2c_f32_bf16 v26, v35, v15
    v_dot2c_f32_bf16 v26, v39, v15
    s_waitcnt vmcnt(2)
    s_barrier
    ds_read_b64_tr_b16 v[32:33], v28 offset:16384
    ds_read_b64_tr_b16 v[34:35], v28 offset:16896
    ds_read_b64_tr_b16 v[36:37], v28 offset:20480
    ds_read_b64_tr_b16 v[38:39], v28 offset:20992
    s_waitcnt lgkmcnt(4)
    v_dot2c_f32_bf16 v26, v40, v15
    v_dot2c_f32_bf16 v26, v44, v15
    v_dot2c_f32_bf16 v26, v41, v15
    v_dot2c_f32_bf16 v26, v45, v15
    v_dot2c_f32_bf16 v26, v42, v15
    v_dot2c_f32_bf16 v26, v46, v15
    v_dot2c_f32_bf16 v26, v43, v15
    v_dot2c_f32_bf16 v26, v47, v15
    s_waitcnt vmcnt(0)
    s_barrier
    ds_read_b64_tr_b16 v[40:41], v28 offset:24576
    ds_read_b64_tr_b16 v[42:43], v28 offset:25088
    ds_read_b64_tr_b16 v[44:45], v28 offset:28672
    ds_read_b64_tr_b16 v[46:47], v28 offset:29184
    s_waitcnt lgkmcnt(4)
    v_dot2c_f32_bf16 v26, v32, v15
    v_dot2c_f32_bf16 v26, v36, v15
    v_dot2c_f32_bf16 v26, v33, v15
    v_dot2c_f32_bf16 v26, v37, v15
    v_dot2c_f32_bf16 v26, v34, v15
    v_dot2c_f32_bf16 v26, v38, v15
    v_dot2c_f32_bf16 v26, v35, v15
    v_dot2c_f32_bf16 v26, v39, v15
    buffer_load_dword v58, v58, s[60:63], 0 offen
    s_waitcnt lgkmcnt(0)
    v_dot2c_f32_bf16 v26, v40, v15
    v_dot2c_f32_bf16 v26, v44, v15
    v_dot2c_f32_bf16 v26, v41, v15
    v_dot2c_f32_bf16 v26, v45, v15
    v_dot2c_f32_bf16 v26, v42, v15
    v_dot2c_f32_bf16 v26, v46, v15
    v_dot2c_f32_bf16 v26, v43, v15
    v_dot2c_f32_bf16 v26, v47, v15
    s_nop 2
    v_mov_b32 v22, v26
    s_nop 1
    v_permlane32_swap_b32 v26, v22
    v_add_f32 v26, v26, v22
    ds_write_b32 v30, v26 offset:1280
    s_waitcnt lgkmcnt(0)
    s_barrier
    ds_read_b32 v22, v60 offset:1024
    ds_read_b32 v23, v60 offset:1408
    s_waitcnt lgkmcnt(0)
    v_add_f32 v22, v22, v23
    ds_write_b32 v61, v22
    s_waitcnt lgkmcnt(0)
    s_barrier
    v_mov_b32 v228, 0x7ffffff0
    v_mov_b32 v229, 1
    s_setprio 0
    s_branch K2_ENTRY
    s_nop 2
K1_COMPUTE:
    s_lshl_b32 s27, s21, 2
    s_add_u32 s27, s27, s25
    s_and_b32 s27, s27, 7
    s_getpc_b64 s[44:45]
K1_PC:
    s_sub_u32 s44, s44, K1_PC-k1_kernel
    s_subb_u32 s45, s45, 0
    s_mov_b32 s46, CODE_END-k1_kernel
    s_mov_b32 s47, 0x00020000
    s_lshl_b32 s27, s27, 12
    v_lshlrev_b32 v1, 6, v2
    buffer_load_dword v1, v1, s[44:47], s27 offen
    s_and_b32 s30, s25, 1
    s_lshr_b32 s31, s25, 1
    v_lshrrev_b32 v3, 5, v2
    v_and_b32 v4, 31, v2
    v_bfe_u32 v8, v2, 2, 2
    v_lshl_add_u32 v8, v3, 3, v8
    v_and_b32 v7, 3, v2
    v_lshlrev_b32 v7, 3, v7
    v_bfe_u32 v9, v2, 4, 1
    v_lshl_add_u32 v7, v9, 5, v7
    v_bfe_u32 v5, v2, 3, 1
    v_lshl_add_u32 v7, v5, 6, v7
    v_lshl_add_u32 v7, v8, 7, v7
    s_lshl_b32 s27, s30, 6
    s_lshl_b32 s28, s30, 11
    s_or_b32 s27, s27, s28
    v_xor_b32 v7, s27, v7
    v_add_u32 v7, 65536, v7
    v_xor_b32 v8, 2048, v7
    v_bfe_u32 v5, v4, 1, 3
    v_xor_b32 v5, v5, v3
    v_lshlrev_b32 v5, 4, v5
    v_lshl_add_u32 v5, v4, 7, v5
    s_lshl_b32 s27, s31, 12
    v_add_u32 v5, s27, v5
    s_lshl_b32 s27, s30, 5
    v_xor_b32 v136, s27, v5
    v_xor_b32 v137, 32, v136
    v_xor_b32 v138, 64, v136
    v_xor_b32 v139, 64, v137
    v_mov_b32 v128, 0
    v_mov_b32 v129, 0
    v_mov_b32 v130, 0
    v_mov_b32 v131, 0
    v_mov_b32 v132, 0x3f803f80
    s_lshl_b32 s26, s22, 6
    s_lshl_b32 s27, s31, 5
    s_add_u32 s26, s26, s27
    s_lshl_b32 s23, s23, 1
    s_add_u32 s23, s23, s30
    s_lshl_b32 s27, s23, 17
    s_lshl_b32 s28, s26, 5
    s_add_u32 s27, s27, s28
    v_lshlrev_b32 v10, 4, v2
    v_add_u32 v10, s27, v10
    v_and_b32 v11, 15, v2
    v_lshlrev_b32 v11, 4, v11
    v_lshl_add_u32 v11, v3, 8, v11
    v_lshl_add_u32 v11, v9, 16, v11
    v_add_u32 v11, s27, v11
    s_mov_b32 s40, 65536
    s_mov_b32 s41, 2097152
    s_mov_b32 s42, 2162688
    s_mov_b32 s43, 4194304
    s_mul_i32 s27, s30, 384
    s_add_u32 s27, s27, 106496
    v_lshlrev_b32 v13, 4, v3
    v_add_u32 v12, s27, v13
    v_lshlrev_b32 v15, 2, v4
    v_add_u32 v14, s27, v15
    s_lshl_b32 s28, s25, 8
    s_add_u32 s28, s28, 106496
    v_add_u32 v13, s28, v13
    v_add_u32 v15, s28, v15
    v_xor_b32 v6, 256, v15
    s_load_dwordx2 s[56:57], s[0:1], 72
    s_waitcnt lgkmcnt(0)
    s_mov_b32 s36, s8
    s_mov_b32 s37, s9
    s_mov_b32 s38, 0x00600000
    s_mov_b32 s39, 0x00020000
    s_add_u32 s48, s8, 0x00600000
    s_addc_u32 s49, s9, 0
    s_mov_b32 s50, 0x00200000
    s_mov_b32 s51, 0x00020000
    s_add_u32 s52, s8, 0x00a00000
    s_addc_u32 s53, s9, 0
    s_mov_b32 s54, 0x000b6600
    s_mov_b32 s55, 0x00020000
    s_mov_b32 s60, s56
    s_mov_b32 s61, s57
    s_mov_b32 s62, 0x00000100
    s_mov_b32 s63, 0x00020000
    v_lshlrev_b32 v140, 4, v2
    s_lshl_b32 s27, s2, 13
    s_lshl_b32 s28, s25, 11
    s_add_u32 s27, s27, s28
    v_add_u32 v141, s27, v140
    s_lshl_b32 s27, s2, 12
    s_lshl_b32 s28, s25, 10
    s_add_u32 s27, s27, s28
    v_add_u32 v140, s27, v140
    v_mov_b32 v144, -1
    v_mov_b32 v145, -1
    v_mov_b32 v146, -1
    v_mov_b32 v147, -1
    s_lshl_b32 s27, s23, 13
    s_lshl_b32 s28, s26, 2
    s_add_u32 s27, s27, s28
    s_add_u32 s27, s27, 593920
    v_mov_b32 v142, s27
    v_mov_b32 v143, 1
    s_and_b32 s27, s2, 63
    s_lshl_b32 s27, s27, 2
    v_mov_b32 v148, s27
    v_lshlrev_b32 v150, 2, v2
    s_mov_b32 s64, s6
    s_mov_b32 s65, s7
    s_mov_b32 s66, 0x00180000
    s_mov_b32 s67, 0x00020000
    s_lshl_b32 s27, s21, 6
    v_add_u32 v230, s27, v2
    v_lshrrev_b32 v231, 2, v230
    v_mul_u32_u24 v231, 3072, v231
    v_and_b32 v230, 3, v230
    v_lshl_add_u32 v230, v230, 7, v231
    s_and_b32 s27, s20, 1
    s_lshl_b32 s27, s27, 9
    s_add_u32 s27, s27, 2048
    s_cmp_eq_u32 s25, 1
    s_cselect_b32 s27, s27, 0x40000000
    v_add_u32 v230, s27, v230
    s_barrier
    s_waitcnt lgkmcnt(0)
    buffer_store_dwordx4 v[144:147], v140, s[52:55], 0 offen sc1
    buffer_store_dwordx4 v[144:147], v141, s[48:51], 0 offen sc1
    buffer_store_dwordx4 v[144:147], v141, s[48:51], 0 offen offset:1024 sc1
    ds_read_b128 v[16:19], v136 offset:0
    ds_read_b128 v[20:23], v137 offset:0
    ds_read_b64_tr_b16 v[32:33], v7 offset:0
    ds_read_b64_tr_b16 v[34:35], v7 offset:512
    ds_read_b64_tr_b16 v[36:37], v7 offset:4096
    ds_read_b64_tr_b16 v[38:39], v7 offset:4608
    ds_read_b64_tr_b16 v[40:41], v8 offset:0
    ds_read_b64_tr_b16 v[42:43], v8 offset:512
    ds_read_b64_tr_b16 v[44:45], v8 offset:4096
    ds_read_b64_tr_b16 v[46:47], v8 offset:4608
    s_barrier
    s_waitcnt lgkmcnt(0)
    v_mfma_f32_32x32x16_bf16 v[80:95], v[32:35], v[16:19], 0
    ds_read_b128 v[48:51], v138 offset:0
    ds_read_b128 v[52:55], v139 offset:0
    ds_read_b64_tr_b16 v[64:65], v7 offset:8192
    v_mfma_f32_32x32x16_bf16 v[96:111], v[36:39], v[16:19], 0
    ds_read_b64_tr_b16 v[66:67], v7 offset:8704
    ds_read_b64_tr_b16 v[68:69], v7 offset:12288
    ds_read_b64_tr_b16 v[70:71], v7 offset:12800
    v_mfma_f32_32x32x16_bf16 v[80:95], v[40:43], v[20:23], v[80:95]
    ds_read_b64_tr_b16 v[72:73], v8 offset:8192
    ds_read_b64_tr_b16 v[74:75], v8 offset:8704
    ds_read_b64_tr_b16 v[76:77], v8 offset:12288
    v_mfma_f32_32x32x16_bf16 v[96:111], v[44:47], v[20:23], v[96:111]
    ds_read_b64_tr_b16 v[78:79], v8 offset:12800
    v_dot2c_f32_bf16 v128, v16, v132
    v_dot2c_f32_bf16 v130, v16, v16
    v_dot2c_f32_bf16 v129, v17, v132
    v_dot2c_f32_bf16 v131, v17, v17
    v_dot2c_f32_bf16 v128, v18, v132
    v_dot2c_f32_bf16 v130, v18, v18
    v_dot2c_f32_bf16 v129, v19, v132
    v_dot2c_f32_bf16 v131, v19, v19
    s_barrier
    s_waitcnt lgkmcnt(0)
    v_mfma_f32_32x32x16_bf16 v[80:95], v[64:67], v[48:51], v[80:95]
    ds_read_b128 v[16:19], v136 offset:8192
    ds_read_b128 v[20:23], v137 offset:8192
    ds_read_b64_tr_b16 v[32:33], v7 offset:16384
    v_mfma_f32_32x32x16_bf16 v[96:111], v[68:71], v[48:51], v[96:111]
    ds_read_b64_tr_b16 v[34:35], v7 offset:16896
    ds_read_b64_tr_b16 v[36:37], v7 offset:20480
    ds_read_b64_tr_b16 v[38:39], v7 offset:20992
    v_mfma_f32_32x32x16_bf16 v[80:95], v[72:75], v[52:55], v[80:95]
    ds_read_b64_tr_b16 v[40:41], v8 offset:16384
    ds_read_b64_tr_b16 v[42:43], v8 offset:16896
    ds_read_b64_tr_b16 v[44:45], v8 offset:20480
    v_mfma_f32_32x32x16_bf16 v[96:111], v[76:79], v[52:55], v[96:111]
    ds_read_b64_tr_b16 v[46:47], v8 offset:20992
    v_dot2c_f32_bf16 v128, v48, v132
    v_dot2c_f32_bf16 v130, v48, v48
    v_dot2c_f32_bf16 v129, v49, v132
    v_dot2c_f32_bf16 v131, v49, v49
    v_dot2c_f32_bf16 v128, v50, v132
    v_dot2c_f32_bf16 v130, v50, v50
    v_dot2c_f32_bf16 v129, v51, v132
    v_dot2c_f32_bf16 v131, v51, v51
    s_barrier
    s_waitcnt lgkmcnt(0)
    v_mfma_f32_32x32x16_bf16 v[80:95], v[32:35], v[16:19], v[80:95]
    ds_read_b128 v[48:51], v138 offset:8192
    ds_read_b128 v[52:55], v139 offset:8192
    ds_read_b64_tr_b16 v[64:65], v7 offset:24576
    v_mfma_f32_32x32x16_bf16 v[96:111], v[36:39], v[16:19], v[96:111]
    ds_read_b64_tr_b16 v[66:67], v7 offset:25088
    ds_read_b64_tr_b16 v[68:69], v7 offset:28672
    ds_read_b64_tr_b16 v[70:71], v7 offset:29184
    v_mfma_f32_32x32x16_bf16 v[80:95], v[40:43], v[20:23], v[80:95]
    ds_read_b64_tr_b16 v[72:73], v8 offset:24576
    ds_read_b64_tr_b16 v[74:75], v8 offset:25088
    ds_read_b64_tr_b16 v[76:77], v8 offset:28672
    v_mfma_f32_32x32x16_bf16 v[96:111], v[44:47], v[20:23], v[96:111]
    ds_read_b64_tr_b16 v[78:79], v8 offset:29184
    v_dot2c_f32_bf16 v128, v16, v132
    v_dot2c_f32_bf16 v130, v16, v16
    v_dot2c_f32_bf16 v129, v17, v132
    v_dot2c_f32_bf16 v131, v17, v17
    v_dot2c_f32_bf16 v128, v18, v132
    v_dot2c_f32_bf16 v130, v18, v18
    v_dot2c_f32_bf16 v129, v19, v132
    v_dot2c_f32_bf16 v131, v19, v19
    s_barrier
    s_waitcnt lgkmcnt(0)
    v_mfma_f32_32x32x16_bf16 v[80:95], v[64:67], v[48:51], v[80:95]
    ds_read_b128 v[16:19], v136 offset:16384
    ds_read_b128 v[20:23], v137 offset:16384
    ds_read_b64_tr_b16 v[32:33], v7 offset:32768
    v_mfma_f32_32x32x16_bf16 v[96:111], v[68:71], v[48:51], v[96:111]
    ds_read_b64_tr_b16 v[34:35], v7 offset:33280
    ds_read_b64_tr_b16 v[36:37], v7 offset:36864
    ds_read_b64_tr_b16 v[38:39], v7 offset:37376
    v_mfma_f32_32x32x16_bf16 v[80:95], v[72:75], v[52:55], v[80:95]
    ds_read_b64_tr_b16 v[40:41], v8 offset:32768
    ds_read_b64_tr_b16 v[42:43], v8 offset:33280
    ds_read_b64_tr_b16 v[44:45], v8 offset:36864
    v_mfma_f32_32x32x16_bf16 v[96:111], v[76:79], v[52:55], v[96:111]
    ds_read_b64_tr_b16 v[46:47], v8 offset:37376
    v_dot2c_f32_bf16 v128, v48, v132
    v_dot2c_f32_bf16 v130, v48, v48
    v_dot2c_f32_bf16 v129, v49, v132
    v_dot2c_f32_bf16 v131, v49, v49
    v_dot2c_f32_bf16 v128, v50, v132
    v_dot2c_f32_bf16 v130, v50, v50
    v_dot2c_f32_bf16 v129, v51, v132
    v_dot2c_f32_bf16 v131, v51, v51
    s_barrier
    s_waitcnt lgkmcnt(0)
    v_mfma_f32_32x32x16_bf16 v[80:95], v[32:35], v[16:19], v[80:95]
    ds_read_b128 v[48:51], v138 offset:16384
    ds_read_b128 v[52:55], v139 offset:16384
    ds_read_b64_tr_b16 v[64:65], v7 offset:0
    v_mfma_f32_32x32x16_bf16 v[96:111], v[36:39], v[16:19], v[96:111]
    ds_read_b64_tr_b16 v[66:67], v7 offset:512
    ds_read_b64_tr_b16 v[68:69], v7 offset:4096
    ds_read_b64_tr_b16 v[70:71], v7 offset:4608
    v_mfma_f32_32x32x16_bf16 v[80:95], v[40:43], v[20:23], v[80:95]
    ds_read_b64_tr_b16 v[72:73], v8 offset:0
    ds_read_b64_tr_b16 v[74:75], v8 offset:512
    ds_read_b64_tr_b16 v[76:77], v8 offset:4096
    v_mfma_f32_32x32x16_bf16 v[96:111], v[44:47], v[20:23], v[96:111]
    ds_read_b64_tr_b16 v[78:79], v8 offset:4608
    v_dot2c_f32_bf16 v128, v16, v132
    v_dot2c_f32_bf16 v130, v16, v16
    v_dot2c_f32_bf16 v129, v17, v132
    v_dot2c_f32_bf16 v131, v17, v17
    v_dot2c_f32_bf16 v128, v18, v132
    v_dot2c_f32_bf16 v130, v18, v18
    v_dot2c_f32_bf16 v129, v19, v132
    v_dot2c_f32_bf16 v131, v19, v19
    s_barrier
    s_waitcnt lgkmcnt(0)
    s_waitcnt vmcnt(0)
    v_mfma_f32_32x32x16_bf16 v[80:95], v[64:67], v[48:51], v[80:95]
    ds_read_b128 v[16:19], v136 offset:24576
    ds_read_b128 v[20:23], v137 offset:24576
    ds_read_b64_tr_b16 v[32:33], v7 offset:8192
    v_mfma_f32_32x32x16_bf16 v[96:111], v[68:71], v[48:51], v[96:111]
    ds_read_b64_tr_b16 v[34:35], v7 offset:8704
    ds_read_b64_tr_b16 v[36:37], v7 offset:12288
    ds_read_b64_tr_b16 v[38:39], v7 offset:12800
    v_mfma_f32_32x32x16_bf16 v[80:95], v[72:75], v[52:55], v[80:95]
    ds_read_b64_tr_b16 v[40:41], v8 offset:8192
    ds_read_b64_tr_b16 v[42:43], v8 offset:8704
    ds_read_b64_tr_b16 v[44:45], v8 offset:12288
    v_mfma_f32_32x32x16_bf16 v[96:111], v[76:79], v[52:55], v[96:111]
    ds_read_b64_tr_b16 v[46:47], v8 offset:12800
    v_dot2c_f32_bf16 v128, v48, v132
    v_dot2c_f32_bf16 v130, v48, v48
    v_dot2c_f32_bf16 v129, v49, v132
    v_dot2c_f32_bf16 v131, v49, v49
    v_dot2c_f32_bf16 v128, v50, v132
    v_dot2c_f32_bf16 v130, v50, v50
    v_dot2c_f32_bf16 v129, v51, v132
    v_dot2c_f32_bf16 v131, v51, v51
    s_barrier
    s_waitcnt lgkmcnt(0)
    s_cmp_lg_u32 s25, 0
    s_cbranch_scc1 K1_NC7
    s_mov_b64 exec, 1
    buffer_atomic_add v143, v148, s[60:63], 0 offen sc1
    s_mov_b64 exec, -1
K1_NC7:
    v_mfma_f32_32x32x16_bf16 v[80:95], v[32:35], v[16:19], v[80:95]
    ds_read_b128 v[48:51], v138 offset:24576
    ds_read_b128 v[52:55], v139 offset:24576
    ds_read_b64_tr_b16 v[64:65], v7 offset:16384
    v_mfma_f32_32x32x16_bf16 v[96:111], v[36:39], v[16:19], v[96:111]
    ds_read_b64_tr_b16 v[66:67], v7 offset:16896
    ds_read_b64_tr_b16 v[68:69], v7 offset:20480
    ds_read_b64_tr_b16 v[70:71], v7 offset:20992
    v_mfma_f32_32x32x16_bf16 v[80:95], v[40:43], v[20:23], v[80:95]
    ds_read_b64_tr_b16 v[72:73], v8 offset:16384
    ds_read_b64_tr_b16 v[74:75], v8 offset:16896
    ds_read_b64_tr_b16 v[76:77], v8 offset:20480
    v_mfma_f32_32x32x16_bf16 v[96:111], v[44:47], v[20:23], v[96:111]
    ds_read_b64_tr_b16 v[78:79], v8 offset:20992
    v_dot2c_f32_bf16 v128, v16, v132
    v_dot2c_f32_bf16 v130, v16, v16
    v_dot2c_f32_bf16 v129, v17, v132
    v_dot2c_f32_bf16 v131, v17, v17
    v_dot2c_f32_bf16 v128, v18, v132
    v_dot2c_f32_bf16 v130, v18, v18
    v_dot2c_f32_bf16 v129, v19, v132
    v_dot2c_f32_bf16 v131, v19, v19
    s_barrier
    s_waitcnt lgkmcnt(0)
    buffer_load_dword v230, v230, s[64:67], 0 offen
    v_mfma_f32_32x32x16_bf16 v[80:95], v[64:67], v[48:51], v[80:95]
    ds_read_b128 v[16:19], v136 offset:32768
    ds_read_b128 v[20:23], v137 offset:32768
    ds_read_b64_tr_b16 v[32:33], v7 offset:24576
    v_mfma_f32_32x32x16_bf16 v[96:111], v[68:71], v[48:51], v[96:111]
    ds_read_b64_tr_b16 v[34:35], v7 offset:25088
    ds_read_b64_tr_b16 v[36:37], v7 offset:28672
    ds_read_b64_tr_b16 v[38:39], v7 offset:29184
    v_mfma_f32_32x32x16_bf16 v[80:95], v[72:75], v[52:55], v[80:95]
    ds_read_b64_tr_b16 v[40:41], v8 offset:24576
    ds_read_b64_tr_b16 v[42:43], v8 offset:25088
    ds_read_b64_tr_b16 v[44:45], v8 offset:28672
    v_mfma_f32_32x32x16_bf16 v[96:111], v[76:79], v[52:55], v[96:111]
    ds_read_b64_tr_b16 v[46:47], v8 offset:29184
    v_dot2c_f32_bf16 v128, v48, v132
    v_dot2c_f32_bf16 v130, v48, v48
    v_dot2c_f32_bf16 v129, v49, v132
    v_dot2c_f32_bf16 v131, v49, v49
    v_dot2c_f32_bf16 v128, v50, v132
    v_dot2c_f32_bf16 v130, v50, v50
    v_dot2c_f32_bf16 v129, v51, v132
    v_dot2c_f32_bf16 v131, v51, v51
    s_barrier
    s_waitcnt lgkmcnt(0)
    v_mfma_f32_32x32x16_bf16 v[80:95], v[32:35], v[16:19], v[80:95]
    ds_read_b128 v[48:51], v138 offset:32768
    ds_read_b128 v[52:55], v139 offset:32768
    ds_read_b64_tr_b16 v[64:65], v7 offset:32768
    v_mfma_f32_32x32x16_bf16 v[96:111], v[36:39], v[16:19], v[96:111]
    ds_read_b64_tr_b16 v[66:67], v7 offset:33280
    ds_read_b64_tr_b16 v[68:69], v7 offset:36864
    ds_read_b64_tr_b16 v[70:71], v7 offset:37376
    v_mfma_f32_32x32x16_bf16 v[80:95], v[40:43], v[20:23], v[80:95]
    ds_read_b64_tr_b16 v[72:73], v8 offset:32768
    ds_read_b64_tr_b16 v[74:75], v8 offset:33280
    ds_read_b64_tr_b16 v[76:77], v8 offset:36864
    v_mfma_f32_32x32x16_bf16 v[96:111], v[44:47], v[20:23], v[96:111]
    ds_read_b64_tr_b16 v[78:79], v8 offset:37376
    v_dot2c_f32_bf16 v128, v16, v132
    v_dot2c_f32_bf16 v130, v16, v16
    v_dot2c_f32_bf16 v129, v17, v132
    v_dot2c_f32_bf16 v131, v17, v17
    v_dot2c_f32_bf16 v128, v18, v132
    v_dot2c_f32_bf16 v130, v18, v18
    v_dot2c_f32_bf16 v129, v19, v132
    v_dot2c_f32_bf16 v131, v19, v19
    s_barrier
    s_waitcnt lgkmcnt(0)
    v_mfma_f32_32x32x16_bf16 v[80:95], v[64:67], v[48:51], v[80:95]
    ds_read_b128 v[16:19], v136 offset:40960
    ds_read_b128 v[20:23], v137 offset:40960
    ds_read_b64_tr_b16 v[32:33], v7 offset:0
    v_mfma_f32_32x32x16_bf16 v[96:111], v[68:71], v[48:51], v[96:111]
    ds_read_b64_tr_b16 v[34:35], v7 offset:512
    ds_read_b64_tr_b16 v[36:37], v7 offset:4096
    ds_read_b64_tr_b16 v[38:39], v7 offset:4608
    v_mfma_f32_32x32x16_bf16 v[80:95], v[72:75], v[52:55], v[80:95]
    ds_read_b64_tr_b16 v[40:41], v8 offset:0
    ds_read_b64_tr_b16 v[42:43], v8 offset:512
    ds_read_b64_tr_b16 v[44:45], v8 offset:4096
    v_mfma_f32_32x32x16_bf16 v[96:111], v[76:79], v[52:55], v[96:111]
    ds_read_b64_tr_b16 v[46:47], v8 offset:4608
    v_dot2c_f32_bf16 v128, v48, v132
    v_dot2c_f32_bf16 v130, v48, v48
    v_dot2c_f32_bf16 v129, v49, v132
    v_dot2c_f32_bf16 v131, v49, v49
    v_dot2c_f32_bf16 v128, v50, v132
    v_dot2c_f32_bf16 v130, v50, v50
    v_dot2c_f32_bf16 v129, v51, v132
    v_dot2c_f32_bf16 v131, v51, v51
    s_barrier
    s_waitcnt lgkmcnt(0)
    v_mfma_f32_32x32x16_bf16 v[80:95], v[32:35], v[16:19], v[80:95]
    ds_read_b128 v[48:51], v138 offset:40960
    ds_read_b128 v[52:55], v139 offset:40960
    ds_read_b64_tr_b16 v[64:65], v7 offset:8192
    v_mfma_f32_32x32x16_bf16 v[96:111], v[36:39], v[16:19], v[96:111]
    ds_read_b64_tr_b16 v[66:67], v7 offset:8704
    ds_read_b64_tr_b16 v[68:69], v7 offset:12288
    ds_read_b64_tr_b16 v[70:71], v7 offset:12800
    v_mfma_f32_32x32x16_bf16 v[80:95], v[40:43], v[20:23], v[80:95]
    ds_read_b64_tr_b16 v[72:73], v8 offset:8192
    ds_read_b64_tr_b16 v[74:75], v8 offset:8704
    ds_read_b64_tr_b16 v[76:77], v8 offset:12288
    v_mfma_f32_32x32x16_bf16 v[96:111], v[44:47], v[20:23], v[96:111]
    ds_read_b64_tr_b16 v[78:79], v8 offset:12800
    v_dot2c_f32_bf16 v128, v16, v132
    v_dot2c_f32_bf16 v130, v16, v16
    v_dot2c_f32_bf16 v129, v17, v132
    v_dot2c_f32_bf16 v131, v17, v17
    v_dot2c_f32_bf16 v128, v18, v132
    v_dot2c_f32_bf16 v130, v18, v18
    v_dot2c_f32_bf16 v129, v19, v132
    v_dot2c_f32_bf16 v131, v19, v19
    s_barrier
    s_waitcnt lgkmcnt(0)
    v_mfma_f32_32x32x16_bf16 v[80:95], v[64:67], v[48:51], v[80:95]
    ds_read_b128 v[16:19], v136 offset:49152
    ds_read_b128 v[20:23], v137 offset:49152
    ds_read_b64_tr_b16 v[32:33], v7 offset:16384
    v_mfma_f32_32x32x16_bf16 v[96:111], v[68:71], v[48:51], v[96:111]
    ds_read_b64_tr_b16 v[34:35], v7 offset:16896
    ds_read_b64_tr_b16 v[36:37], v7 offset:20480
    ds_read_b64_tr_b16 v[38:39], v7 offset:20992
    v_mfma_f32_32x32x16_bf16 v[80:95], v[72:75], v[52:55], v[80:95]
    ds_read_b64_tr_b16 v[40:41], v8 offset:16384
    ds_read_b64_tr_b16 v[42:43], v8 offset:16896
    ds_read_b64_tr_b16 v[44:45], v8 offset:20480
    v_mfma_f32_32x32x16_bf16 v[96:111], v[76:79], v[52:55], v[96:111]
    ds_read_b64_tr_b16 v[46:47], v8 offset:20992
    v_dot2c_f32_bf16 v128, v48, v132
    v_dot2c_f32_bf16 v130, v48, v48
    v_dot2c_f32_bf16 v129, v49, v132
    v_dot2c_f32_bf16 v131, v49, v49
    v_dot2c_f32_bf16 v128, v50, v132
    v_dot2c_f32_bf16 v130, v50, v50
    v_dot2c_f32_bf16 v129, v51, v132
    v_dot2c_f32_bf16 v131, v51, v51
    s_barrier
    s_waitcnt lgkmcnt(0)
    v_mfma_f32_32x32x16_bf16 v[80:95], v[32:35], v[16:19], v[80:95]
    ds_read_b128 v[48:51], v138 offset:49152
    ds_read_b128 v[52:55], v139 offset:49152
    ds_read_b64_tr_b16 v[64:65], v7 offset:24576
    v_mfma_f32_32x32x16_bf16 v[96:111], v[36:39], v[16:19], v[96:111]
    ds_read_b64_tr_b16 v[66:67], v7 offset:25088
    ds_read_b64_tr_b16 v[68:69], v7 offset:28672
    ds_read_b64_tr_b16 v[70:71], v7 offset:29184
    v_mfma_f32_32x32x16_bf16 v[80:95], v[40:43], v[20:23], v[80:95]
    ds_read_b64_tr_b16 v[72:73], v8 offset:24576
    ds_read_b64_tr_b16 v[74:75], v8 offset:25088
    ds_read_b64_tr_b16 v[76:77], v8 offset:28672
    v_mfma_f32_32x32x16_bf16 v[96:111], v[44:47], v[20:23], v[96:111]
    ds_read_b64_tr_b16 v[78:79], v8 offset:29184
    v_dot2c_f32_bf16 v128, v16, v132
    v_dot2c_f32_bf16 v130, v16, v16
    v_dot2c_f32_bf16 v129, v17, v132
    v_dot2c_f32_bf16 v131, v17, v17
    v_dot2c_f32_bf16 v128, v18, v132
    v_dot2c_f32_bf16 v130, v18, v18
    v_dot2c_f32_bf16 v129, v19, v132
    v_dot2c_f32_bf16 v131, v19, v19
    s_barrier
    s_waitcnt lgkmcnt(0)
    v_mfma_f32_32x32x16_bf16 v[80:95], v[64:67], v[48:51], v[80:95]
    ds_read_b128 v[16:19], v136 offset:57344
    ds_read_b128 v[20:23], v137 offset:57344
    ds_read_b64_tr_b16 v[32:33], v7 offset:32768
    v_mfma_f32_32x32x16_bf16 v[96:111], v[68:71], v[48:51], v[96:111]
    ds_read_b64_tr_b16 v[34:35], v7 offset:33280
    ds_read_b64_tr_b16 v[36:37], v7 offset:36864
    ds_read_b64_tr_b16 v[38:39], v7 offset:37376
    v_mfma_f32_32x32x16_bf16 v[80:95], v[72:75], v[52:55], v[80:95]
    ds_read_b64_tr_b16 v[40:41], v8 offset:32768
    ds_read_b64_tr_b16 v[42:43], v8 offset:33280
    ds_read_b64_tr_b16 v[44:45], v8 offset:36864
    v_mfma_f32_32x32x16_bf16 v[96:111], v[76:79], v[52:55], v[96:111]
    ds_read_b64_tr_b16 v[46:47], v8 offset:37376
    v_dot2c_f32_bf16 v128, v48, v132
    v_dot2c_f32_bf16 v130, v48, v48
    v_dot2c_f32_bf16 v129, v49, v132
    v_dot2c_f32_bf16 v131, v49, v49
    v_dot2c_f32_bf16 v128, v50, v132
    v_dot2c_f32_bf16 v130, v50, v50
    v_dot2c_f32_bf16 v129, v51, v132
    v_dot2c_f32_bf16 v131, v51, v51
    s_barrier
    s_waitcnt lgkmcnt(0)
    v_mfma_f32_32x32x16_bf16 v[80:95], v[32:35], v[16:19], v[80:95]
    ds_read_b128 v[48:51], v138 offset:57344
    ds_read_b128 v[52:55], v139 offset:57344
    ds_read_b64_tr_b16 v[64:65], v7 offset:0
    v_mfma_f32_32x32x16_bf16 v[96:111], v[36:39], v[16:19], v[96:111]
    ds_read_b64_tr_b16 v[66:67], v7 offset:512
    ds_read_b64_tr_b16 v[68:69], v7 offset:4096
    ds_read_b64_tr_b16 v[70:71], v7 offset:4608
    v_mfma_f32_32x32x16_bf16 v[80:95], v[40:43], v[20:23], v[80:95]
    ds_read_b64_tr_b16 v[72:73], v8 offset:0
    ds_read_b64_tr_b16 v[74:75], v8 offset:512
    ds_read_b64_tr_b16 v[76:77], v8 offset:4096
    v_mfma_f32_32x32x16_bf16 v[96:111], v[44:47], v[20:23], v[96:111]
    ds_read_b64_tr_b16 v[78:79], v8 offset:4608
    v_dot2c_f32_bf16 v128, v16, v132
    v_dot2c_f32_bf16 v130, v16, v16
    v_dot2c_f32_bf16 v129, v17, v132
    v_dot2c_f32_bf16 v131, v17, v17
    v_dot2c_f32_bf16 v128, v18, v132
    v_dot2c_f32_bf16 v130, v18, v18
    v_dot2c_f32_bf16 v129, v19, v132
    v_dot2c_f32_bf16 v131, v19, v19
    s_waitcnt lgkmcnt(9)
    v_dot2c_f32_bf16 v128, v48, v132
    v_dot2c_f32_bf16 v130, v48, v48
    v_dot2c_f32_bf16 v129, v49, v132
    v_dot2c_f32_bf16 v131, v49, v49
    v_dot2c_f32_bf16 v128, v50, v132
    v_dot2c_f32_bf16 v130, v50, v50
    v_dot2c_f32_bf16 v129, v51, v132
    v_dot2c_f32_bf16 v131, v51, v51
    s_nop 1
    v_add_f32 v128, v128, v129
    v_add_f32 v130, v130, v131
    v_mov_b32 v129, v128
    v_mov_b32 v131, v130
    s_nop 0
    v_permlane32_swap_b32 v128, v129
    v_permlane32_swap_b32 v130, v131
    v_add_f32 v128, v128, v129
    v_add_f32 v130, v130, v131
    ds_write_b32 v15, v128 offset:2560
    ds_write_b32 v15, v130 offset:2688
    s_waitcnt lgkmcnt(0)
    v_mfma_f32_32x32x16_bf16 v[80:95], v[64:67], v[48:51], v[80:95]
    v_mfma_f32_32x32x16_bf16 v[96:111], v[68:71], v[48:51], v[96:111]
    s_barrier
    ds_read_b32 v129, v6 offset:2560
    ds_read_b32 v131, v6 offset:2688
    v_mfma_f32_32x32x16_bf16 v[80:95], v[72:75], v[52:55], v[80:95]
    v_mfma_f32_32x32x16_bf16 v[96:111], v[76:79], v[52:55], v[96:111]
    s_waitcnt lgkmcnt(0)
    v_add_f32 v128, v128, v129
    v_add_f32 v130, v130, v131
    v_mul_f32 v129, 0x3b000000, v128
    v_mul_f32 v133, 0x3b000000, v130
    v_fma_f32 v133, -v129, v129, v133
    v_max_f32 v133, 0, v133
    v_cvt_pk_bf16_f32 v133, v133, v133
    v_and_b32 v133, 0xffff0000, v133
    v_add_f32 v133, 0x3727c5ac, v133
    v_cvt_pk_bf16_f32 v133, v133, v133
    v_and_b32 v133, 0xffff0000, v133
    v_sqrt_f32 v133, v133
    v_cvt_pk_bf16_f32 v129, v129, v129
    v_and_b32 v129, 0xffff0000, v129
    v_cvt_pk_bf16_f32 v133, v133, v133
    v_and_b32 v133, 0xffff0000, v133
    v_rcp_f32 v133, v133
    s_nop 0
    v_mul_f32 v134, v129, v133
    v_sub_f32 v134, 0, v134
    ds_write_b32 v15, v133 offset:3584
    ds_write_b32 v15, v134 offset:3712
    v_mul_f32 v135, 0x3eb8aa3b, v133
    v_mul_f32 v151, 0x3eb8aa3b, v134
    s_waitcnt lgkmcnt(0)
    s_barrier
    ds_read_b128 v[168:171], v12 offset:128
    ds_read_b128 v[172:175], v12 offset:160
    ds_read_b128 v[176:179], v12 offset:192
    ds_read_b128 v[180:183], v12 offset:224
    ds_read_b128 v[152:155], v12 offset:0
    ds_read_b128 v[156:159], v12 offset:32
    ds_read_b128 v[160:163], v12 offset:64
    ds_read_b128 v[164:167], v12 offset:96
    v_mul_f32 v96, v96, v133
    v_mul_f32 v97, v97, v133
    v_mul_f32 v98, v98, v133
    v_mul_f32 v99, v99, v133
    v_mul_f32 v100, v100, v133
    v_mul_f32 v101, v101, v133
    v_mul_f32 v102, v102, v133
    v_mul_f32 v103, v103, v133
    v_mul_f32 v104, v104, v133
    v_mul_f32 v105, v105, v133
    v_mul_f32 v106, v106, v133
    v_mul_f32 v107, v107, v133
    v_mul_f32 v108, v108, v133
    v_mul_f32 v109, v109, v133
    v_mul_f32 v110, v110, v133
    v_mul_f32 v111, v111, v133
    v_mul_f32 v80, v80, v135
    v_mul_f32 v81, v81, v135
    v_mul_f32 v82, v82, v135
    v_mul_f32 v83, v83, v135
    v_mul_f32 v84, v84, v135
    v_mul_f32 v85, v85, v135
    v_mul_f32 v86, v86, v135
    v_mul_f32 v87, v87, v135
    v_mul_f32 v88, v88, v135
    v_mul_f32 v89, v89, v135
    v_mul_f32 v90, v90, v135
    v_mul_f32 v91, v91, v135
    v_mul_f32 v92, v92, v135
    v_mul_f32 v93, v93, v135
    v_mul_f32 v94, v94, v135
    v_mul_f32 v95, v95, v135
    s_waitcnt lgkmcnt(4)
    v_fmac_f32 v96, v168, v134
    v_fmac_f32 v97, v169, v134
    v_fmac_f32 v98, v170, v134
    v_fmac_f32 v99, v171, v134
    v_fmac_f32 v100, v172, v134
    v_fmac_f32 v101, v173, v134
    v_fmac_f32 v102, v174, v134
    v_fmac_f32 v103, v175, v134
    v_fmac_f32 v104, v176, v134
    v_fmac_f32 v105, v177, v134
    v_fmac_f32 v106, v178, v134
    v_fmac_f32 v107, v179, v134
    v_fmac_f32 v108, v180, v134
    v_fmac_f32 v109, v181, v134
    v_fmac_f32 v110, v182, v134
    v_fmac_f32 v111, v183, v134
    v_cvt_pk_bf16_f32 v168, v96, v97
    v_cvt_pk_bf16_f32 v169, v98, v99
    v_cvt_pk_bf16_f32 v170, v100, v101
    v_cvt_pk_bf16_f32 v171, v102, v103
    v_cvt_pk_bf16_f32 v172, v104, v105
    v_cvt_pk_bf16_f32 v173, v106, v107
    v_cvt_pk_bf16_f32 v174, v108, v109
    v_cvt_pk_bf16_f32 v175, v110, v111
    buffer_store_dwordx4 v[168:171], v10, s[36:39], s41 offen sc1
    buffer_store_dwordx4 v[172:175], v10, s[36:39], s42 offen sc1
    s_waitcnt lgkmcnt(0)
    v_fmac_f32 v80, v152, v151
    v_fmac_f32 v81, v153, v151
    v_fmac_f32 v82, v154, v151
    v_fmac_f32 v83, v155, v151
    v_fmac_f32 v84, v156, v151
    v_fmac_f32 v85, v157, v151
    v_fmac_f32 v86, v158, v151
    v_fmac_f32 v87, v159, v151
    v_fmac_f32 v88, v160, v151
    v_fmac_f32 v89, v161, v151
    v_fmac_f32 v90, v162, v151
    v_fmac_f32 v91, v163, v151
    v_fmac_f32 v92, v164, v151
    v_fmac_f32 v93, v165, v151
    v_fmac_f32 v94, v166, v151
    v_fmac_f32 v95, v167, v151
    v_cvt_pk_bf16_f32 v152, v80, v81
    v_cvt_pk_bf16_f32 v153, v82, v83
    v_cvt_pk_bf16_f32 v154, v84, v85
    v_cvt_pk_bf16_f32 v155, v86, v87
    v_cvt_pk_bf16_f32 v156, v88, v89
    v_cvt_pk_bf16_f32 v157, v90, v91
    v_cvt_pk_bf16_f32 v158, v92, v93
    v_cvt_pk_bf16_f32 v159, v94, v95
    buffer_store_dwordx4 v[152:155], v10, s[36:39], 0 offen sc1
    buffer_store_dwordx4 v[156:159], v10, s[36:39], s40 offen sc1
    s_barrier
    s_waitcnt lgkmcnt(0)
    ds_read_b128 v[16:19], v136 offset:0
    ds_read_b64_tr_b16 v[32:33], v7 offset:8192
    ds_read_b64_tr_b16 v[34:35], v7 offset:8704
    ds_read_b128 v[20:23], v137 offset:0
    ds_read_b64_tr_b16 v[36:37], v8 offset:8192
    ds_read_b64_tr_b16 v[38:39], v8 offset:8704
    ds_read_b128 v[24:27], v138 offset:0
    ds_read_b64_tr_b16 v[40:41], v7 offset:12288
    ds_read_b64_tr_b16 v[42:43], v7 offset:12800
    ds_read_b128 v[28:31], v139 offset:0
    ds_read_b64_tr_b16 v[44:45], v8 offset:12288
    ds_read_b64_tr_b16 v[46:47], v8 offset:12800
    s_barrier
    s_waitcnt lgkmcnt(0)
    s_cmp_lg_u32 s25, 0
    s_cbranch_scc1 K1_NC17
    buffer_load_dword v149, v150, s[60:63], 0 offen sc1
K1_NC17:
    v_mfma_f32_32x32x16_bf16 v[112:127], v[16:19], v[32:35], 0
    ds_read_b128 v[48:51], v136 offset:8192
    ds_read_b64_tr_b16 v[64:65], v7 offset:16384
    ds_read_b64_tr_b16 v[66:67], v7 offset:16896
    v_mfma_f32_32x32x16_bf16 v[112:127], v[20:23], v[36:39], v[112:127]
    ds_read_b128 v[52:55], v137 offset:8192
    ds_read_b64_tr_b16 v[68:69], v8 offset:16384
    ds_read_b64_tr_b16 v[70:71], v8 offset:16896
    v_mfma_f32_32x32x16_bf16 v[112:127], v[24:27], v[40:43], v[112:127]
    ds_read_b128 v[56:59], v138 offset:8192
    ds_read_b64_tr_b16 v[72:73], v7 offset:20480
    ds_read_b64_tr_b16 v[74:75], v7 offset:20992
    v_mfma_f32_32x32x16_bf16 v[112:127], v[28:31], v[44:47], v[112:127]
    ds_read_b128 v[60:63], v139 offset:8192
    ds_read_b64_tr_b16 v[76:77], v8 offset:20480
    ds_read_b64_tr_b16 v[78:79], v8 offset:20992
    s_barrier
    s_waitcnt lgkmcnt(0)
    v_mfma_f32_32x32x16_bf16 v[112:127], v[48:51], v[64:67], v[112:127]
    ds_read_b128 v[16:19], v136 offset:16384
    ds_read_b64_tr_b16 v[32:33], v7 offset:24576
    ds_read_b64_tr_b16 v[34:35], v7 offset:25088
    v_mfma_f32_32x32x16_bf16 v[112:127], v[52:55], v[68:71], v[112:127]
    ds_read_b128 v[20:23], v137 offset:16384
    ds_read_b64_tr_b16 v[36:37], v8 offset:24576
    ds_read_b64_tr_b16 v[38:39], v8 offset:25088
    v_mfma_f32_32x32x16_bf16 v[112:127], v[56:59], v[72:75], v[112:127]
    ds_read_b128 v[24:27], v138 offset:16384
    ds_read_b64_tr_b16 v[40:41], v7 offset:28672
    ds_read_b64_tr_b16 v[42:43], v7 offset:29184
    v_mfma_f32_32x32x16_bf16 v[112:127], v[60:63], v[76:79], v[112:127]
    ds_read_b128 v[28:31], v139 offset:16384
    ds_read_b64_tr_b16 v[44:45], v8 offset:28672
    ds_read_b64_tr_b16 v[46:47], v8 offset:29184
    s_barrier
    s_waitcnt lgkmcnt(0)
    v_mfma_f32_32x32x16_bf16 v[112:127], v[16:19], v[32:35], v[112:127]
    ds_read_b128 v[48:51], v136 offset:24576
    ds_read_b64_tr_b16 v[64:65], v7 offset:32768
    ds_read_b64_tr_b16 v[66:67], v7 offset:33280
    v_mfma_f32_32x32x16_bf16 v[112:127], v[20:23], v[36:39], v[112:127]
    ds_read_b128 v[52:55], v137 offset:24576
    ds_read_b64_tr_b16 v[68:69], v8 offset:32768
    ds_read_b64_tr_b16 v[70:71], v8 offset:33280
    v_mfma_f32_32x32x16_bf16 v[112:127], v[24:27], v[40:43], v[112:127]
    ds_read_b128 v[56:59], v138 offset:24576
    ds_read_b64_tr_b16 v[72:73], v7 offset:36864
    ds_read_b64_tr_b16 v[74:75], v7 offset:37376
    v_mfma_f32_32x32x16_bf16 v[112:127], v[28:31], v[44:47], v[112:127]
    ds_read_b128 v[60:63], v139 offset:24576
    ds_read_b64_tr_b16 v[76:77], v8 offset:36864
    ds_read_b64_tr_b16 v[78:79], v8 offset:37376
    s_barrier
    s_waitcnt lgkmcnt(0)
    v_mfma_f32_32x32x16_bf16 v[112:127], v[48:51], v[64:67], v[112:127]
    ds_read_b128 v[16:19], v136 offset:32768
    ds_read_b64_tr_b16 v[32:33], v7 offset:0
    ds_read_b64_tr_b16 v[34:35], v7 offset:512
    v_mfma_f32_32x32x16_bf16 v[112:127], v[52:55], v[68:71], v[112:127]
    ds_read_b128 v[20:23], v137 offset:32768
    ds_read_b64_tr_b16 v[36:37], v8 offset:0
    ds_read_b64_tr_b16 v[38:39], v8 offset:512
    v_mfma_f32_32x32x16_bf16 v[112:127], v[56:59], v[72:75], v[112:127]
    ds_read_b128 v[24:27], v138 offset:32768
    ds_read_b64_tr_b16 v[40:41], v7 offset:4096
    ds_read_b64_tr_b16 v[42:43], v7 offset:4608
    v_mfma_f32_32x32x16_bf16 v[112:127], v[60:63], v[76:79], v[112:127]
    ds_read_b128 v[28:31], v139 offset:32768
    ds_read_b64_tr_b16 v[44:45], v8 offset:4096
    ds_read_b64_tr_b16 v[46:47], v8 offset:4608
    s_cmp_lg_u32 s25, 0
    s_cbranch_scc1 K1_CLR
    s_mov_b32 s35, 400000
K1_CLP:
    s_waitcnt vmcnt(0)
    v_cmp_gt_u32 vcc, 4, v149
    s_nop 4
    s_cbranch_vccz K1_CLR
    s_sleep 4
    buffer_load_dword v149, v150, s[60:63], 0 offen sc1
    s_sub_u32 s35, s35, 1
    s_cmp_lg_u32 s35, 0
    s_cbranch_scc1 K1_CLP
K1_CLR:
    s_barrier
    s_waitcnt lgkmcnt(0)
    s_waitcnt vmcnt(0)
    s_mov_b64 exec, 1
    buffer_store_dword v143, v142, s[52:55], 0 offen sc1
    s_mov_b64 exec, -1
    v_mfma_f32_32x32x16_bf16 v[112:127], v[16:19], v[32:35], v[112:127]
    ds_read_b128 v[48:51], v136 offset:40960
    ds_read_b64_tr_b16 v[64:65], v7 offset:8192
    ds_read_b64_tr_b16 v[66:67], v7 offset:8704
    v_mfma_f32_32x32x16_bf16 v[112:127], v[20:23], v[36:39], v[112:127]
    ds_read_b128 v[52:55], v137 offset:40960
    ds_read_b64_tr_b16 v[68:69], v8 offset:8192
    ds_read_b64_tr_b16 v[70:71], v8 offset:8704
    v_mfma_f32_32x32x16_bf16 v[112:127], v[24:27], v[40:43], v[112:127]
    ds_read_b128 v[56:59], v138 offset:40960
    ds_read_b64_tr_b16 v[72:73], v7 offset:12288
    ds_read_b64_tr_b16 v[74:75], v7 offset:12800
    v_mfma_f32_32x32x16_bf16 v[112:127], v[28:31], v[44:47], v[112:127]
    ds_read_b128 v[60:63], v139 offset:40960
    ds_read_b64_tr_b16 v[76:77], v8 offset:12288
    ds_read_b64_tr_b16 v[78:79], v8 offset:12800
    s_barrier
    s_waitcnt lgkmcnt(0)
    v_mfma_f32_32x32x16_bf16 v[112:127], v[48:51], v[64:67], v[112:127]
    ds_read_b128 v[16:19], v136 offset:49152
    ds_read_b64_tr_b16 v[32:33], v7 offset:16384
    ds_read_b64_tr_b16 v[34:35], v7 offset:16896
    v_mfma_f32_32x32x16_bf16 v[112:127], v[52:55], v[68:71], v[112:127]
    ds_read_b128 v[20:23], v137 offset:49152
    ds_read_b64_tr_b16 v[36:37], v8 offset:16384
    ds_read_b64_tr_b16 v[38:39], v8 offset:16896
    v_mfma_f32_32x32x16_bf16 v[112:127], v[56:59], v[72:75], v[112:127]
    ds_read_b128 v[24:27], v138 offset:49152
    ds_read_b64_tr_b16 v[40:41], v7 offset:20480
    ds_read_b64_tr_b16 v[42:43], v7 offset:20992
    v_mfma_f32_32x32x16_bf16 v[112:127], v[60:63], v[76:79], v[112:127]
    ds_read_b128 v[28:31], v139 offset:49152
    ds_read_b64_tr_b16 v[44:45], v8 offset:20480
    ds_read_b64_tr_b16 v[46:47], v8 offset:20992
    s_barrier
    s_waitcnt lgkmcnt(0)
    v_mfma_f32_32x32x16_bf16 v[112:127], v[16:19], v[32:35], v[112:127]
    ds_read_b128 v[48:51], v136 offset:57344
    ds_read_b64_tr_b16 v[64:65], v7 offset:24576
    ds_read_b64_tr_b16 v[66:67], v7 offset:25088
    v_mfma_f32_32x32x16_bf16 v[112:127], v[20:23], v[36:39], v[112:127]
    ds_read_b128 v[52:55], v137 offset:57344
    ds_read_b64_tr_b16 v[68:69], v8 offset:24576
    ds_read_b64_tr_b16 v[70:71], v8 offset:25088
    v_mfma_f32_32x32x16_bf16 v[112:127], v[24:27], v[40:43], v[112:127]
    ds_read_b128 v[56:59], v138 offset:57344
    ds_read_b64_tr_b16 v[72:73], v7 offset:28672
    ds_read_b64_tr_b16 v[74:75], v7 offset:29184
    v_mfma_f32_32x32x16_bf16 v[112:127], v[28:31], v[44:47], v[112:127]
    ds_read_b128 v[60:63], v139 offset:57344
    ds_read_b64_tr_b16 v[76:77], v8 offset:28672
    ds_read_b64_tr_b16 v[78:79], v8 offset:29184
    s_waitcnt lgkmcnt(0)
    v_mfma_f32_32x32x16_bf16 v[112:127], v[48:51], v[64:67], v[112:127]
    v_mfma_f32_32x32x16_bf16 v[112:127], v[52:55], v[68:71], v[112:127]
    s_barrier
    ds_read_b128 v[184:187], v13 offset:3584
    ds_read_b128 v[200:203], v13 offset:3712
    ds_read_b128 v[188:191], v13 offset:3616
    ds_read_b128 v[204:207], v13 offset:3744
    ds_read_b128 v[192:195], v13 offset:3648
    ds_read_b128 v[208:211], v13 offset:3776
    ds_read_b128 v[196:199], v13 offset:3680
    ds_read_b128 v[212:215], v13 offset:3808
    v_mfma_f32_32x32x16_bf16 v[112:127], v[56:59], v[72:75], v[112:127]
    v_mfma_f32_32x32x16_bf16 v[112:127], v[60:63], v[76:79], v[112:127]
    s_barrier
    ds_read_b32 v5, v14 offset:256
    s_waitcnt lgkmcnt(1)
    s_nop 8
    v_mul_f32 v112, v112, v184
    v_mul_f32 v113, v113, v185
    v_mul_f32 v114, v114, v186
    v_mul_f32 v115, v115, v187
    v_mul_f32 v116, v116, v188
    v_mul_f32 v117, v117, v189
    v_mul_f32 v118, v118, v190
    v_mul_f32 v119, v119, v191
    v_mul_f32 v120, v120, v192
    v_mul_f32 v121, v121, v193
    v_mul_f32 v122, v122, v194
    v_mul_f32 v123, v123, v195
    v_mul_f32 v124, v124, v196
    v_mul_f32 v125, v125, v197
    v_mul_f32 v126, v126, v198
    v_mul_f32 v127, v127, v199
    s_waitcnt lgkmcnt(0)
    v_fmac_f32 v112, v200, v5
    v_fmac_f32 v113, v201, v5
    v_fmac_f32 v114, v202, v5
    v_fmac_f32 v115, v203, v5
    v_fmac_f32 v116, v204, v5
    v_fmac_f32 v117, v205, v5
    v_fmac_f32 v118, v206, v5
    v_fmac_f32 v119, v207, v5
    v_fmac_f32 v120, v208, v5
    v_fmac_f32 v121, v209, v5
    v_fmac_f32 v122, v210, v5
    v_fmac_f32 v123, v211, v5
    v_fmac_f32 v124, v212, v5
    v_fmac_f32 v125, v213, v5
    v_fmac_f32 v126, v214, v5
    v_fmac_f32 v127, v215, v5
    v_cvt_pk_bf16_f32 v220, v112, v113
    v_cvt_pk_bf16_f32 v221, v114, v115
    v_cvt_pk_bf16_f32 v222, v116, v117
    v_cvt_pk_bf16_f32 v223, v118, v119
    v_cvt_pk_bf16_f32 v224, v120, v121
    v_cvt_pk_bf16_f32 v225, v122, v123
    v_cvt_pk_bf16_f32 v226, v124, v125
    v_cvt_pk_bf16_f32 v227, v126, v127
    buffer_store_dwordx4 v[220:223], v11, s[36:39], s43 offen sc1
    buffer_store_dwordx4 v[224:227], v11, s[36:39], s43 offen offset:512 sc1
    v_mov_b32 v228, v142
    v_mov_b32 v229, 1
    s_nop 4
K2_ENTRY:
    s_load_dwordx2 s[8:9], s[0:1], 80
    s_load_dwordx2 s[4:5], s[0:1], 16
    s_load_dwordx4 s[72:75], s[0:1], 40
    s_load_dwordx2 s[76:77], s[0:1], 56
    v_lshrrev_b32 v1, 6, v0
    v_and_b32 v2, 63, v0
    v_readfirstlane_b32 s25, v1
    s_and_b32 s20, s2, 7
    s_lshr_b32 s21, s2, 3
    s_and_b32 s22, s21, 3
    s_lshl_b32 s23, s20, 2
    s_add_u32 s22, s22, s23
    s_lshr_b32 s23, s21, 2
    s_lshl_b32 s23, s23, 3
    s_add_u32 s24, s23, s25
    s_lshl_b32 s26, s22, 16
    s_lshl_b32 s27, s24, 10
    s_add_u32 s26, s26, s27
    v_lshlrev_b32 v5, 4, v2
    v_add_u32 v3, s26, v5
    s_lshl_b32 s36, s25, 10
    s_add_u32 s36, s36, 118784
    s_mov_b32 s37, 8192
    s_waitcnt lgkmcnt(0)
    s_add_u32 s16, s8, 0x001fe000
    s_addc_u32 s17, s9, 0
    s_mov_b32 s18, 0x00202000
    s_mov_b32 s19, 0x00020000
    s_mov_b32 s12, s8
    s_mov_b32 s13, s9
    s_mov_b32 s14, 0x00200000
    s_mov_b32 s15, 0x00020000
    s_add_u32 s28, s8, 0x003fe000
    s_addc_u32 s29, s9, 0
    s_mov_b32 s30, 0x00202000
    s_mov_b32 s31, 0x00020000
    s_cmp_lt_u32 s24, 8
    s_cselect_b32 s33, 8192, 0
    s_mov_b32 s78, s33
    s_add_u32 s32, s8, 0x00600000
    s_addc_u32 s33, s9, 0
    s_mov_b32 s34, 0x00200000
    s_mov_b32 s35, 0x00020000
    v_add_u32 v208, s36, v5
    v_and_b32 v4, 15, v2
    v_lshlrev_b32 v4, 4, v4
    v_lshrrev_b32 v5, 5, v2
    v_lshl_add_u32 v4, v5, 8, v4
    v_add_u32 v4, s36, v4
    v_and_b32 v6, 16, v2
    v_cmp_eq_u32 vcc, 0, v6
    v_mov_b32 v6, 135168
    s_nop 0
    v_cndmask_b32 v4, v6, v4, vcc
    v_mov_b32 v48, 0x3f803f80
    v_mov_b32 v49, 0x3f803f80
    v_mov_b32 v50, 0x3f803f80
    v_mov_b32 v51, 0x3f803f80
    v_min_u32 v6, 17, v2
    v_lshlrev_b32 v6, 9, v6
    v_add_u32 v6, 118784, v6
    ds_write_b128 v6, v[48:51] offset:32768
    s_mov_b32 s40, 0xffffffff
    s_mov_b32 s41, 0xfffffff0
    s_mov_b32 s42, 0xfffffffe
    s_mov_b32 s43, 0xffffffe0
    s_mov_b32 s44, 0xfffffffc
    s_mov_b32 s45, 0xffffffc0
    s_mov_b32 s46, 0xfffffff8
    s_mov_b32 s47, 0xffffff80
    s_mov_b32 s48, 0xffffff00
    s_mov_b32 s49, 0xfffff000
    s_mov_b32 s50, 0xfffffe00
    s_mov_b32 s51, 0xffffe000
    s_mov_b32 s52, 0xfffffc00
    s_mov_b32 s53, 0xffffc000
    s_mov_b32 s54, 0xfffff800
    s_mov_b32 s55, 0xffff8000
    s_mov_b32 s56, 0xffff0000
    s_mov_b32 s57, 0xfff00000
    s_mov_b32 s58, 0xfffe0000
    s_mov_b32 s59, 0xffe00000
    s_mov_b32 s60, 0xfffc0000
    s_mov_b32 s61, 0xffc00000
    s_mov_b32 s62, 0xfff80000
    s_mov_b32 s63, 0xff800000
    s_mov_b32 s64, 0xff000000
    s_mov_b32 s65, 0xf0000000
    s_mov_b32 s66, 0xfe000000
    s_mov_b32 s67, 0xe0000000
    s_mov_b32 s68, 0xfc000000
    s_mov_b32 s69, 0xc0000000
    s_mov_b32 s70, 0xf8000000
    s_mov_b32 s71, 0x80000000
    s_lshr_b32 s38, s25, 1
    s_lshl_b32 s38, s38, 3
    s_and_b32 s39, s25, 1
    s_lshl_b32 s39, s39, 1
    s_add_u32 s38, s38, s39
    v_and_b32 v6, 31, v2
    v_lshlrev_b32 v5, 2, v5
    v_sub_u32 v6, v6, v5
    v_subrev_u32 v6, s38, v6
    v_mov_b32 v7, 0xffff
    v_cmp_lt_i32 vcc, 0, v6
    s_nop 1
    v_cndmask_b32 v7, v7, -1, vcc
    v_cmp_gt_i32 vcc, 0, v6
    s_nop 1
    v_cndmask_b32 v7, v7, 0, vcc
    v_lshlrev_b32 v212, 5, v2
    v_add_u32 v212, 118784, v212
    s_lshl_b32 s38, s25, 2
    v_add_u32 v6, s38, v212
    ds_write_b32 v6, v7 offset:43008
    s_mov_b32 s39, s78
    s_add_u32 s20, s8, 0x00a00000
    s_addc_u32 s21, s9, 0
    s_mov_b32 s22, 0x000b6600
    s_mov_b32 s23, 0x00020000
    v_lshlrev_b32 v213, 4, v2
    s_lshl_b32 s26, s25, 10
    s_add_u32 s26, s26, 65536
    v_add_u32 v213, s26, v213
    v_mov_b32 v214, 0x7ffffff0
    v_mov_b32 v215, 0x7ffffff0
    s_cmp_ge_u32 s25, 4
    s_cbranch_scc1 K2_LD
    s_waitcnt vmcnt(0)
    s_mov_b64 exec, 1
    buffer_store_dword v229, v228, s[20:23], 0 offen offset:64 sc1
    s_mov_b64 exec, -1
    s_waitcnt lgkmcnt(0)
    s_branch K2_LDJ
K2_LD:
    s_and_b32 s26, s24, -8
    s_sub_u32 s27, s25, 4
    s_lshl_b32 s38, s27, 2
    s_cmp_lt_u32 s38, 8
    s_cselect_b32 s39, s78, 0
    v_lshrrev_b32 v6, 16, v3
    v_lshlrev_b32 v214, 16, v6
    v_lshrrev_b32 v6, 1, v6
    v_lshlrev_b32 v6, 13, v6
    s_add_u32 s79, s26, s38
    s_lshr_b32 s37, s39, 10
    s_add_u32 s79, s79, s37
    s_lshl_b32 s37, s79, 7
    s_add_u32 s37, s37, 592896
    v_lshl_add_u32 v6, v2, 7, v6
    v_add_u32 v215, s37, v6
    s_lshl_b32 s37, s27, 1
    s_add_u32 s37, s37, s26
    s_lshl_b32 s26, s37, 7
    s_add_u32 s26, s26, 593408
    v_add_u32 v6, s26, v6
    v_cmp_gt_u32 vcc, 4, v2
    s_nop 1
    v_cndmask_b32 v6, v6, v215, vcc
    v_lshl_add_u32 v214, v2, 4, v214
    s_lshl_b32 s79, s79, 10
    s_lshl_b32 s37, s37, 10
    s_lshl_b32 s38, s38, 10
    s_add_u32 s38, s38, 118784
    s_lshl_b32 s27, s27, 11
    s_add_u32 s27, s27, 65536
    s_mov_b64 exec, 0x3f
    s_mov_b32 s26, 400000
    s_nop 0
K2_PF:
    s_sleep 2
    buffer_load_dword v7, v6, s[20:23], 0 offen sc1
    s_sub_u32 s26, s26, 1
    s_waitcnt vmcnt(0)
    v_mov_b32 v8, v7
    v_cmp_eq_u32 vcc, -1, v8
    s_cmp_eq_u32 s26, 0
    s_cbranch_scc1 K2_PFX
    s_nop 3
    s_cbranch_vccnz K2_PF
K2_PFX:
    s_mov_b64 exec, -1
    s_mov_b32 m0, s38
    s_nop 0
    buffer_load_dwordx4 v214, s[16:19], s79 offen offset:0 sc1 lds
    buffer_load_dwordx4 v214, s[16:19], s79 offen offset:1024 sc1 lds
    buffer_load_dwordx4 v214, s[16:19], s79 offen offset:2048 sc1 lds
    buffer_load_dwordx4 v214, s[16:19], s79 offen offset:3072 sc1 lds
    s_mov_b32 m0, s27
    s_nop 0
    buffer_load_dwordx4 v214, s[12:15], s37 offen offset:0 sc1 lds
    buffer_load_dwordx4 v214, s[12:15], s37 offen offset:1024 sc1 lds
    s_waitcnt vmcnt(0) lgkmcnt(0)
    s_nop 0
K2_LDJ:
    s_barrier
    ds_read_b128 v[8:11], v213
    s_cmp_lt_u32 s25, 4
    s_cbranch_scc1 K2_NOV
    s_mov_b64 exec, 0xf
    s_mov_b32 s26, 400000
    s_nop 0
K2_PV:
    s_sleep 2
    buffer_load_dword v7, v215, s[20:23], 0 offen offset:64 sc1
    s_sub_u32 s26, s26, 1
    s_waitcnt vmcnt(0)
    v_mov_b32 v6, v7
    v_cmp_eq_u32 vcc, -1, v6
    s_cmp_eq_u32 s26, 0
    s_cbranch_scc1 K2_PVX
    s_nop 3
    s_cbranch_vccnz K2_PV
K2_PVX:
    s_mov_b64 exec, -1
    s_add_u32 m0, s38, 16384
    s_nop 0
    buffer_load_dwordx4 v214, s[28:31], s79 offen offset:0 sc1 lds
    buffer_load_dwordx4 v214, s[28:31], s79 offen offset:1024 sc1 lds
    buffer_load_dwordx4 v214, s[28:31], s79 offen offset:2048 sc1 lds
    buffer_load_dwordx4 v214, s[28:31], s79 offen offset:3072 sc1 lds
    s_nop 1
K2_NOV:
    ds_read_b128 v[44:47], v208 offset:8192
    ds_read_b128 v[12:15], v208 offset:0
    ds_read_b128 v[40:43], v208 offset:7168
    ds_read_b128 v[36:39], v208 offset:6144
    ds_read_b128 v[32:35], v208 offset:5120
    ds_read_b128 v[28:31], v208 offset:4096
    ds_read_b128 v[24:27], v208 offset:3072
    ds_read_b128 v[20:23], v208 offset:2048
    ds_read_b128 v[16:19], v208 offset:1024
    s_waitcnt lgkmcnt(8)
    v_mfma_f32_32x32x16_bf16 v[120:135], v[44:47], v[8:11], 0
    s_cmp_lt_u32 s24, 8
    s_cbranch_scc1 K2_NEG1
    s_waitcnt lgkmcnt(7)
    v_mfma_f32_32x32x16_bf16 v[136:151], v[12:15], v[8:11], 0
    s_branch K2_J1
    s_nop 10
K2_NEG1:
    v_mov_b32 v136, 0xf149f2ca
    v_mov_b32 v137, 0xf149f2ca
    v_mov_b32 v138, 0xf149f2ca
    v_mov_b32 v139, 0xf149f2ca
    v_mov_b32 v140, 0xf149f2ca
    v_mov_b32 v141, 0xf149f2ca
    v_mov_b32 v142, 0xf149f2ca
    v_mov_b32 v143, 0xf149f2ca
    v_mov_b32 v144, 0xf149f2ca
    v_mov_b32 v145, 0xf149f2ca
    v_mov_b32 v146, 0xf149f2ca
    v_mov_b32 v147, 0xf149f2ca
    v_mov_b32 v148, 0xf149f2ca
    v_mov_b32 v149, 0xf149f2ca
    v_mov_b32 v150, 0xf149f2ca
    v_mov_b32 v151, 0xf149f2ca
    s_nop 4
K2_J1:
    s_waitcnt lgkmcnt(0)
    v_mfma_f32_32x32x16_bf16 v[152:167], v[40:43], v[8:11], 0
    s_nop 7
    s_nop 3
    v_cndmask_b32 v120, v136, v120, s[40:41]
    v_cndmask_b32 v121, v137, v121, s[42:43]
    v_cndmask_b32 v122, v138, v122, s[44:45]
    v_cndmask_b32 v123, v139, v123, s[46:47]
    v_cndmask_b32 v124, v140, v124, s[48:49]
    v_cndmask_b32 v125, v141, v125, s[50:51]
    v_cndmask_b32 v126, v142, v126, s[52:53]
    v_cndmask_b32 v127, v143, v127, s[54:55]
    v_cndmask_b32 v128, v144, v128, s[56:57]
    v_cndmask_b32 v129, v145, v129, s[58:59]
    v_cndmask_b32 v130, v146, v130, s[60:61]
    v_cndmask_b32 v131, v147, v131, s[62:63]
    v_cndmask_b32 v132, v148, v132, s[64:65]
    v_cndmask_b32 v133, v149, v133, s[66:67]
    v_cndmask_b32 v134, v150, v134, s[68:69]
    v_cndmask_b32 v135, v151, v135, s[70:71]
    v_max3_f32 v5, v120, v121, v122
    v_max3_f32 v6, v123, v124, v125
    v_max3_f32 v5, v5, v126, v127
    v_max3_f32 v6, v6, v128, v129
    v_max3_f32 v5, v5, v130, v131
    v_max3_f32 v6, v6, v132, v133
    v_max3_f32 v5, v5, v134, v135
    s_cmp_lt_u32 s24, 1
    s_cbranch_scc1 K2_P1END
    v_mfma_f32_32x32x16_bf16 v[136:151], v[36:39], v[8:11], 0
    v_max3_f32 v5, v5, v152, v153
    v_max3_f32 v6, v6, v154, v155
    v_max3_f32 v5, v5, v156, v157
    v_max3_f32 v6, v6, v158, v159
    v_max3_f32 v5, v5, v160, v161
    v_max3_f32 v6, v6, v162, v163
    v_max3_f32 v5, v5, v164, v165
    v_max3_f32 v6, v6, v166, v167
    s_cmp_lt_u32 s24, 2
    s_cbranch_scc1 K2_P1END
    v_mfma_f32_32x32x16_bf16 v[152:167], v[32:35], v[8:11], 0
    s_nop 0
    v_max3_f32 v5, v5, v136, v137
    v_max3_f32 v6, v6, v138, v139
    v_max3_f32 v5, v5, v140, v141
    v_max3_f32 v6, v6, v142, v143
    v_max3_f32 v5, v5, v144, v145
    v_max3_f32 v6, v6, v146, v147
    v_max3_f32 v5, v5, v148, v149
    v_max3_f32 v6, v6, v150, v151
    s_cmp_lt_u32 s24, 3
    s_cbranch_scc1 K2_P1END
    v_mfma_f32_32x32x16_bf16 v[136:151], v[28:31], v[8:11], 0
    v_max3_f32 v5, v5, v152, v153
    v_max3_f32 v6, v6, v154, v155
    v_max3_f32 v5, v5, v156, v157
    v_max3_f32 v6, v6, v158, v159
    v_max3_f32 v5, v5, v160, v161
    v_max3_f32 v6, v6, v162, v163
    v_max3_f32 v5, v5, v164, v165
    v_max3_f32 v6, v6, v166, v167
    s_cmp_lt_u32 s24, 4
    s_cbranch_scc1 K2_P1END
    v_mfma_f32_32x32x16_bf16 v[152:167], v[24:27], v[8:11], 0
    s_nop 0
    v_max3_f32 v5, v5, v136, v137
    v_max3_f32 v6, v6, v138, v139
    v_max3_f32 v5, v5, v140, v141
    v_max3_f32 v6, v6, v142, v143
    v_max3_f32 v5, v5, v144, v145
    v_max3_f32 v6, v6, v146, v147
    v_max3_f32 v5, v5, v148, v149
    v_max3_f32 v6, v6, v150, v151
    s_cmp_lt_u32 s24, 5
    s_cbranch_scc1 K2_P1END
    v_mfma_f32_32x32x16_bf16 v[136:151], v[20:23], v[8:11], 0
    v_max3_f32 v5, v5, v152, v153
    v_max3_f32 v6, v6, v154, v155
    v_max3_f32 v5, v5, v156, v157
    v_max3_f32 v6, v6, v158, v159
    v_max3_f32 v5, v5, v160, v161
    v_max3_f32 v6, v6, v162, v163
    v_max3_f32 v5, v5, v164, v165
    v_max3_f32 v6, v6, v166, v167
    s_cmp_lt_u32 s24, 6
    s_cbranch_scc1 K2_P1END
    v_mfma_f32_32x32x16_bf16 v[152:167], v[16:19], v[8:11], 0
    s_nop 0
    v_max3_f32 v5, v5, v136, v137
    v_max3_f32 v6, v6, v138, v139
    v_max3_f32 v5, v5, v140, v141
    v_max3_f32 v6, v6, v142, v143
    v_max3_f32 v5, v5, v144, v145
    v_max3_f32 v6, v6, v146, v147
    v_max3_f32 v5, v5, v148, v149
    v_max3_f32 v6, v6, v150, v151
    s_cmp_lt_u32 s24, 7
    s_cbranch_scc1 K2_P1END
    s_nop 0
    v_max3_f32 v5, v5, v152, v153
    v_max3_f32 v6, v6, v154, v155
    v_max3_f32 v5, v5, v156, v157
    v_max3_f32 v6, v6, v158, v159
    v_max3_f32 v5, v5, v160, v161
    v_max3_f32 v6, v6, v162, v163
    v_max3_f32 v5, v5, v164, v165
    v_max3_f32 v6, v6, v166, v167
    s_nop 4
K2_P1END:
    s_waitcnt vmcnt(0)
    s_barrier
    ds_read_b128 v[112:115], v4 offset:24576
    ds_read_b128 v[116:119], v4 offset:25088
    ds_read_b128 v[48:51], v4 offset:16384
    ds_read_b128 v[52:55], v4 offset:16896
    ds_read_b128 v[104:107], v4 offset:23552
    ds_read_b128 v[108:111], v4 offset:24064
    ds_read_b128 v[96:99], v4 offset:22528
    ds_read_b128 v[100:103], v4 offset:23040
    ds_read_b128 v[88:91], v4 offset:21504
    ds_read_b128 v[92:95], v4 offset:22016
    ds_read_b128 v[80:83], v4 offset:20480
    ds_read_b128 v[84:87], v4 offset:20992
    s_cmp_lt_u32 s25, 4
    s_cbranch_scc1 K2_TOUCH
    s_sub_u32 s26, s25, 4
    s_lshr_b32 s27, s2, 3
    s_mov_b32 s20, s4
    s_mov_b32 s21, s5
    s_mov_b32 s22, 0x00080000
    s_mov_b32 s23, 0x00020000
    v_lshrrev_b32 v209, 3, v2
    v_and_b32 v210, 7, v2
    v_bfe_u32 v211, v209, 1, 1
    v_lshlrev_b32 v211, 2, v211
    v_xor_b32 v210, v210, v211
    v_lshlrev_b32 v210, 4, v210
    v_lshl_add_u32 v209, v209, 10, v210
    s_lshl_b32 s38, s26, 17
    s_and_b32 s39, s27, 7
    s_lshl_b32 s39, s39, 7
    s_add_u32 s38, s38, s39
    v_add_u32 v209, s38, v209
    s_mul_i32 s38, s26, 17408
    s_add_u32 m0, s38, 0
    s_mov_b32 s39, 0
    buffer_load_dwordx4 v209, s[20:23], s39 offen lds
    s_add_u32 m0, s38, 1024
    s_mov_b32 s39, 8192
    buffer_load_dwordx4 v209, s[20:23], s39 offen lds
    s_add_u32 m0, s38, 2048
    s_mov_b32 s39, 16384
    buffer_load_dwordx4 v209, s[20:23], s39 offen lds
    s_add_u32 m0, s38, 3072
    s_mov_b32 s39, 24576
    buffer_load_dwordx4 v209, s[20:23], s39 offen lds
    s_add_u32 m0, s38, 4096
    s_mov_b32 s39, 32768
    buffer_load_dwordx4 v209, s[20:23], s39 offen lds
    s_add_u32 m0, s38, 5120
    s_mov_b32 s39, 40960
    buffer_load_dwordx4 v209, s[20:23], s39 offen lds
    s_add_u32 m0, s38, 6144
    s_mov_b32 s39, 49152
    buffer_load_dwordx4 v209, s[20:23], s39 offen lds
    s_add_u32 m0, s38, 7168
    s_mov_b32 s39, 57344
    buffer_load_dwordx4 v209, s[20:23], s39 offen lds
    s_add_u32 m0, s38, 8192
    s_mov_b32 s39, 65536
    buffer_load_dwordx4 v209, s[20:23], s39 offen lds
    s_add_u32 m0, s38, 9216
    s_mov_b32 s39, 73728
    buffer_load_dwordx4 v209, s[20:23], s39 offen lds
    s_add_u32 m0, s38, 10240
    s_mov_b32 s39, 81920
    buffer_load_dwordx4 v209, s[20:23], s39 offen lds
    s_add_u32 m0, s38, 11264
    s_mov_b32 s39, 90112
    buffer_load_dwordx4 v209, s[20:23], s39 offen lds
    s_add_u32 m0, s38, 12288
    s_mov_b32 s39, 98304
    buffer_load_dwordx4 v209, s[20:23], s39 offen lds
    s_add_u32 m0, s38, 13312
    s_mov_b32 s39, 106496
    buffer_load_dwordx4 v209, s[20:23], s39 offen lds
    s_add_u32 m0, s38, 14336
    s_mov_b32 s39, 114688
    buffer_load_dwordx4 v209, s[20:23], s39 offen lds
    s_add_u32 m0, s38, 15360
    s_mov_b32 s39, 122880
    buffer_load_dwordx4 v209, s[20:23], s39 offen lds
    v_mov_b32 v209, 0x7ffffff0
    s_branch K2_NOPRE
    s_nop 3
K2_TOUCH:
    s_lshr_b32 s26, s2, 3
    s_and_b32 s27, s2, 7
    s_cmp_eq_u32 s25, 0
    s_cselect_b32 s20, s72, s74
    s_cselect_b32 s21, s73, s75
    s_cmp_lt_u32 s25, 2
    s_cselect_b32 s20, s20, s76
    s_cselect_b32 s21, s21, s77
    s_cselect_b64 vcc, -1, 0
    s_mov_b32 s22, 1409024
    s_mov_b32 s23, 0x00020000
    s_lshl_b32 s38, s26, 6
    v_add_u32 v209, s38, v2
    v_lshrrev_b32 v210, 2, v209
    v_mul_u32_u24 v210, 2752, v210
    v_and_b32 v211, 3, v209
    v_lshl_add_u32 v210, v211, 7, v210
    s_mul_i32 s38, s27, 352
    v_add_u32 v210, s38, v210
    v_lshlrev_b32 v209, 10, v209
    s_lshl_b32 s38, s27, 7
    v_add_u32 v209, s38, v209
    v_cndmask_b32 v209, v209, v210, vcc
    s_lshr_b32 s38, s25, 1
    s_and_b32 s38, s38, s25
    s_lshl_b32 s38, s38, 30
    v_or_b32 v209, s38, v209
    s_nop 4
K2_NOPRE:
    v_max_f32 v5, v5, v6
    v_mov_b32 v6, v5
    s_nop 1
    v_permlane32_swap_b32 v5, v6
    v_max_f32 v5, v5, v6
    v_sub_f32 v5, 0, v5
    v_mov_b32 v168, v5
    v_mov_b32 v169, v5
    v_mov_b32 v170, v5
    v_mov_b32 v171, v5
    v_mov_b32 v172, v5
    v_mov_b32 v173, v5
    v_mov_b32 v174, v5
    v_mov_b32 v175, v5
    v_mov_b32 v176, v5
    v_mov_b32 v177, v5
    v_mov_b32 v178, v5
    v_mov_b32 v179, v5
    v_mov_b32 v180, v5
    v_mov_b32 v181, v5
    v_mov_b32 v182, v5
    v_mov_b32 v183, v5
    ds_read_b128 v[72:75], v4 offset:19456
    ds_read_b128 v[76:79], v4 offset:19968
    ds_read_b128 v[64:67], v4 offset:18432
    ds_read_b128 v[68:71], v4 offset:18944
    ds_read_b128 v[56:59], v4 offset:17408
    ds_read_b128 v[60:63], v4 offset:17920
    ds_read_b128 v[200:203], v212 offset:43008
    ds_read_b128 v[204:207], v212 offset:43024
    v_mfma_f32_32x32x16_bf16 v[152:167], v[40:43], v[8:11], v[168:183]
    v_add_f32 v120, v120, v5
    v_add_f32 v121, v121, v5
    v_add_f32 v122, v122, v5
    v_add_f32 v123, v123, v5
    v_add_f32 v124, v124, v5
    v_add_f32 v125, v125, v5
    v_add_f32 v126, v126, v5
    v_add_f32 v127, v127, v5
    v_add_f32 v128, v128, v5
    v_add_f32 v129, v129, v5
    v_add_f32 v130, v130, v5
    v_add_f32 v131, v131, v5
    v_add_f32 v132, v132, v5
    v_add_f32 v133, v133, v5
    v_add_f32 v134, v134, v5
    v_add_f32 v135, v135, v5
    v_exp_f32 v120, v120
    v_exp_f32 v121, v121
    v_exp_f32 v122, v122
    v_exp_f32 v123, v123
    v_cvt_pk_bf16_f32 v120, v120, v121
    v_exp_f32 v124, v124
    v_exp_f32 v125, v125
    v_cvt_pk_bf16_f32 v121, v122, v123
    v_exp_f32 v126, v126
    v_exp_f32 v127, v127
    v_cvt_pk_bf16_f32 v122, v124, v125
    v_exp_f32 v128, v128
    v_exp_f32 v129, v129
    v_cvt_pk_bf16_f32 v123, v126, v127
    v_exp_f32 v130, v130
    v_exp_f32 v131, v131
    v_cvt_pk_bf16_f32 v124, v128, v129
    v_exp_f32 v132, v132
    v_exp_f32 v133, v133
    v_cvt_pk_bf16_f32 v125, v130, v131
    v_exp_f32 v134, v134
    v_exp_f32 v135, v135
    v_cvt_pk_bf16_f32 v126, v132, v133
    v_cvt_pk_bf16_f32 v127, v134, v135
    s_waitcnt lgkmcnt(0)
    v_bfi_b32 v128, v200, 0, v120
    v_and_b32 v120, v120, v200
    v_bfi_b32 v129, v201, 0, v121
    v_and_b32 v121, v121, v201
    v_bfi_b32 v130, v202, 0, v122
    v_and_b32 v122, v122, v202
    v_bfi_b32 v131, v203, 0, v123
    v_and_b32 v123, v123, v203
    v_bfi_b32 v132, v204, 0, v124
    v_and_b32 v124, v124, v204
    v_bfi_b32 v133, v205, 0, v125
    v_and_b32 v125, v125, v205
    v_bfi_b32 v134, v206, 0, v126
    v_and_b32 v126, v126, v206
    v_bfi_b32 v135, v207, 0, v127
    v_and_b32 v127, v127, v207
    s_cmp_lt_u32 s24, 1
    s_cbranch_scc1 K2_X7
    v_exp_f32 v152, v152
    v_exp_f32 v153, v153
    v_mfma_f32_32x32x16_bf16 v[136:151], v[36:39], v[8:11], v[168:183]
    v_exp_f32 v154, v154
    v_exp_f32 v155, v155
    v_mfma_f32_32x32x16_bf16 v[184:199], v[112:115], v[120:123], 0
    v_cvt_pk_bf16_f32 v152, v152, v153
    v_exp_f32 v156, v156
    v_exp_f32 v157, v157
    v_cvt_pk_bf16_f32 v153, v154, v155
    v_exp_f32 v158, v158
    v_exp_f32 v159, v159
    v_mfma_f32_32x32x16_bf16 v[184:199], v[116:119], v[124:127], v[184:199]
    v_cvt_pk_bf16_f32 v154, v156, v157
    v_exp_f32 v160, v160
    v_exp_f32 v161, v161
    v_cvt_pk_bf16_f32 v155, v158, v159
    v_exp_f32 v162, v162
    v_exp_f32 v163, v163
    v_mfma_f32_32x32x16_bf16 v[184:199], v[48:51], v[128:131], v[184:199]
    v_cvt_pk_bf16_f32 v156, v160, v161
    v_exp_f32 v164, v164
    v_exp_f32 v165, v165
    v_cvt_pk_bf16_f32 v157, v162, v163
    v_exp_f32 v166, v166
    v_exp_f32 v167, v167
    v_mfma_f32_32x32x16_bf16 v[184:199], v[52:55], v[132:135], v[184:199]
    v_cvt_pk_bf16_f32 v158, v164, v165
    v_cvt_pk_bf16_f32 v159, v166, v167
    s_cmp_lt_u32 s24, 2
    s_cbranch_scc1 K2_X6
    v_exp_f32 v136, v136
    v_exp_f32 v137, v137
    v_mfma_f32_32x32x16_bf16 v[184:199], v[104:107], v[152:155], v[184:199]
    v_exp_f32 v138, v138
    v_exp_f32 v139, v139
    v_cvt_pk_bf16_f32 v136, v136, v137
    v_exp_f32 v140, v140
    v_exp_f32 v141, v141
    v_mfma_f32_32x32x16_bf16 v[184:199], v[108:111], v[156:159], v[184:199]
    v_cvt_pk_bf16_f32 v137, v138, v139
    v_exp_f32 v142, v142
    v_exp_f32 v143, v143
    v_cvt_pk_bf16_f32 v138, v140, v141
    v_exp_f32 v144, v144
    v_exp_f32 v145, v145
    v_mfma_f32_32x32x16_bf16 v[120:135], v[32:35], v[8:11], v[168:183]
    v_cvt_pk_bf16_f32 v139, v142, v143
    v_exp_f32 v146, v146
    v_exp_f32 v147, v147
    v_cvt_pk_bf16_f32 v140, v144, v145
    v_exp_f32 v148, v148
    v_exp_f32 v149, v149
    v_cvt_pk_bf16_f32 v141, v146, v147
    v_exp_f32 v150, v150
    v_exp_f32 v151, v151
    v_cvt_pk_bf16_f32 v142, v148, v149
    v_cvt_pk_bf16_f32 v143, v150, v151
    s_cmp_lt_u32 s24, 3
    s_cbranch_scc1 K2_X5
    buffer_load_dword v209, v209, s[20:23], 0 offen
    v_exp_f32 v120, v120
    v_exp_f32 v121, v121
    v_mfma_f32_32x32x16_bf16 v[184:199], v[96:99], v[136:139], v[184:199]
    v_exp_f32 v122, v122
    v_exp_f32 v123, v123
    v_cvt_pk_bf16_f32 v120, v120, v121
    v_exp_f32 v124, v124
    v_exp_f32 v125, v125
    v_mfma_f32_32x32x16_bf16 v[184:199], v[100:103], v[140:143], v[184:199]
    v_cvt_pk_bf16_f32 v121, v122, v123
    v_exp_f32 v126, v126
    v_exp_f32 v127, v127
    v_cvt_pk_bf16_f32 v122, v124, v125
    v_exp_f32 v128, v128
    v_exp_f32 v129, v129
    v_mfma_f32_32x32x16_bf16 v[152:167], v[28:31], v[8:11], v[168:183]
    v_cvt_pk_bf16_f32 v123, v126, v127
    v_exp_f32 v130, v130
    v_exp_f32 v131, v131
    v_cvt_pk_bf16_f32 v124, v128, v129
    v_exp_f32 v132, v132
    v_exp_f32 v133, v133
    v_cvt_pk_bf16_f32 v125, v130, v131
    v_exp_f32 v134, v134
    v_exp_f32 v135, v135
    v_cvt_pk_bf16_f32 v126, v132, v133
    v_cvt_pk_bf16_f32 v127, v134, v135
    s_cmp_lt_u32 s24, 4
    s_cbranch_scc1 K2_X4
    v_exp_f32 v152, v152
    v_exp_f32 v153, v153
    v_mfma_f32_32x32x16_bf16 v[184:199], v[88:91], v[120:123], v[184:199]
    v_exp_f32 v154, v154
    v_exp_f32 v155, v155
    v_cvt_pk_bf16_f32 v152, v152, v153
    v_exp_f32 v156, v156
    v_exp_f32 v157, v157
    v_mfma_f32_32x32x16_bf16 v[184:199], v[92:95], v[124:127], v[184:199]
    v_cvt_pk_bf16_f32 v153, v154, v155
    v_exp_f32 v158, v158
    v_exp_f32 v159, v159
    v_cvt_pk_bf16_f32 v154, v156, v157
    v_exp_f32 v160, v160
    v_exp_f32 v161, v161
    v_mfma_f32_32x32x16_bf16 v[136:151], v[24:27], v[8:11], v[168:183]
    v_cvt_pk_bf16_f32 v155, v158, v159
    v_exp_f32 v162, v162
    v_exp_f32 v163, v163
    v_cvt_pk_bf16_f32 v156, v160, v161
    v_exp_f32 v164, v164
    v_exp_f32 v165, v165
    v_cvt_pk_bf16_f32 v157, v162, v163
    v_exp_f32 v166, v166
    v_exp_f32 v167, v167
    v_cvt_pk_bf16_f32 v158, v164, v165
    v_cvt_pk_bf16_f32 v159, v166, v167
    s_cmp_lt_u32 s24, 5
    s_cbranch_scc1 K2_X3
    v_exp_f32 v136, v136
    v_exp_f32 v137, v137
    v_mfma_f32_32x32x16_bf16 v[184:199], v[80:83], v[152:155], v[184:199]
    v_exp_f32 v138, v138
    v_exp_f32 v139, v139
    v_cvt_pk_bf16_f32 v136, v136, v137
    v_exp_f32 v140, v140
    v_exp_f32 v141, v141
    v_mfma_f32_32x32x16_bf16 v[184:199], v[84:87], v[156:159], v[184:199]
    v_cvt_pk_bf16_f32 v137, v138, v139
    v_exp_f32 v142, v142
    v_exp_f32 v143, v143
    v_cvt_pk_bf16_f32 v138, v140, v141
    v_exp_f32 v144, v144
    v_exp_f32 v145, v145
    v_mfma_f32_32x32x16_bf16 v[120:135], v[20:23], v[8:11], v[168:183]
    v_cvt_pk_bf16_f32 v139, v142, v143
    v_exp_f32 v146, v146
    v_exp_f32 v147, v147
    v_cvt_pk_bf16_f32 v140, v144, v145
    v_exp_f32 v148, v148
    v_exp_f32 v149, v149
    v_cvt_pk_bf16_f32 v141, v146, v147
    v_exp_f32 v150, v150
    v_exp_f32 v151, v151
    v_cvt_pk_bf16_f32 v142, v148, v149
    v_cvt_pk_bf16_f32 v143, v150, v151
    s_cmp_lt_u32 s24, 6
    s_cbranch_scc1 K2_X2
    v_exp_f32 v120, v120
    v_exp_f32 v121, v121
    v_mfma_f32_32x32x16_bf16 v[184:199], v[72:75], v[136:139], v[184:199]
    v_exp_f32 v122, v122
    v_exp_f32 v123, v123
    v_cvt_pk_bf16_f32 v120, v120, v121
    v_exp_f32 v124, v124
    v_exp_f32 v125, v125
    v_mfma_f32_32x32x16_bf16 v[184:199], v[76:79], v[140:143], v[184:199]
    v_cvt_pk_bf16_f32 v121, v122, v123
    v_exp_f32 v126, v126
    v_exp_f32 v127, v127
    v_cvt_pk_bf16_f32 v122, v124, v125
    v_exp_f32 v128, v128
    v_exp_f32 v129, v129
    v_mfma_f32_32x32x16_bf16 v[152:167], v[16:19], v[8:11], v[168:183]
    v_cvt_pk_bf16_f32 v123, v126, v127
    v_exp_f32 v130, v130
    v_exp_f32 v131, v131
    v_cvt_pk_bf16_f32 v124, v128, v129
    v_exp_f32 v132, v132
    v_exp_f32 v133, v133
    v_cvt_pk_bf16_f32 v125, v130, v131
    v_exp_f32 v134, v134
    v_exp_f32 v135, v135
    v_cvt_pk_bf16_f32 v126, v132, v133
    v_cvt_pk_bf16_f32 v127, v134, v135
    s_cmp_lt_u32 s24, 7
    s_cbranch_scc1 K2_X1
    v_exp_f32 v152, v152
    v_exp_f32 v153, v153
    v_mfma_f32_32x32x16_bf16 v[184:199], v[64:67], v[120:123], v[184:199]
    v_exp_f32 v154, v154
    v_exp_f32 v155, v155
    v_cvt_pk_bf16_f32 v152, v152, v153
    v_exp_f32 v156, v156
    v_exp_f32 v157, v157
    v_mfma_f32_32x32x16_bf16 v[184:199], v[68:71], v[124:127], v[184:199]
    v_cvt_pk_bf16_f32 v153, v154, v155
    v_exp_f32 v158, v158
    v_exp_f32 v159, v159
    v_cvt_pk_bf16_f32 v154, v156, v157
    v_exp_f32 v160, v160
    v_exp_f32 v161, v161
    v_cvt_pk_bf16_f32 v155, v158, v159
    v_exp_f32 v162, v162
    v_exp_f32 v163, v163
    v_cvt_pk_bf16_f32 v156, v160, v161
    v_exp_f32 v164, v164
    v_exp_f32 v165, v165
    v_cvt_pk_bf16_f32 v157, v162, v163
    v_exp_f32 v166, v166
    v_exp_f32 v167, v167
    v_cvt_pk_bf16_f32 v158, v164, v165
    v_cvt_pk_bf16_f32 v159, v166, v167
    v_mfma_f32_32x32x16_bf16 v[184:199], v[56:59], v[152:155], v[184:199]
    s_nop 0
    v_mfma_f32_32x32x16_bf16 v[184:199], v[60:63], v[156:159], v[184:199]
K2_P2END:
    s_nop 7
    s_nop 3
    v_rcp_f32 v5, v192
    s_nop 0
    v_mul_f32 v184, v184, v5
    v_mul_f32 v185, v185, v5
    v_mul_f32 v186, v186, v5
    v_mul_f32 v187, v187, v5
    v_mul_f32 v188, v188, v5
    v_mul_f32 v189, v189, v5
    v_mul_f32 v190, v190, v5
    v_mul_f32 v191, v191, v5
    v_cvt_pk_bf16_f32 v168, v184, v185
    v_cvt_pk_bf16_f32 v169, v186, v187
    v_cvt_pk_bf16_f32 v170, v188, v189
    v_cvt_pk_bf16_f32 v171, v190, v191
    v_min_u32 v168, -2, v168
    v_min_u32 v169, -2, v169
    v_min_u32 v170, -2, v170
    v_min_u32 v171, -2, v171
    s_waitcnt vmcnt(1)
    buffer_store_dwordx4 v[168:171], v3, s[32:35], 0 offen sc1
    s_branch K3_ENTRY
    s_nop 1
K2_X7:
    s_nop 1
    v_mfma_f32_32x32x16_bf16 v[184:199], v[112:115], v[120:123], 0
    v_mfma_f32_32x32x16_bf16 v[184:199], v[116:119], v[124:127], v[184:199]
    v_mfma_f32_32x32x16_bf16 v[184:199], v[48:51], v[128:131], v[184:199]
    v_mfma_f32_32x32x16_bf16 v[184:199], v[52:55], v[132:135], v[184:199]
    buffer_load_dword v209, v209, s[20:23], 0 offen
    s_branch K2_P2END
    s_nop 9
K2_X6:
    s_nop 1
    v_mfma_f32_32x32x16_bf16 v[184:199], v[104:107], v[152:155], v[184:199]
    v_mfma_f32_32x32x16_bf16 v[184:199], v[108:111], v[156:159], v[184:199]
    buffer_load_dword v209, v209, s[20:23], 0 offen
    s_branch K2_P2END
    s_nop 9
K2_X5:
    s_nop 1
    v_mfma_f32_32x32x16_bf16 v[184:199], v[96:99], v[136:139], v[184:199]
    v_mfma_f32_32x32x16_bf16 v[184:199], v[100:103], v[140:143], v[184:199]
    buffer_load_dword v209, v209, s[20:23], 0 offen
    s_branch K2_P2END
    s_nop 9
K2_X4:
    s_nop 1
    v_mfma_f32_32x32x16_bf16 v[184:199], v[88:91], v[120:123], v[184:199]
    v_mfma_f32_32x32x16_bf16 v[184:199], v[92:95], v[124:127], v[184:199]
    s_branch K2_P2END
    s_nop 10
K2_X3:
    s_nop 1
    v_mfma_f32_32x32x16_bf16 v[184:199], v[80:83], v[152:155], v[184:199]
    v_mfma_f32_32x32x16_bf16 v[184:199], v[84:87], v[156:159], v[184:199]
    s_branch K2_P2END
    s_nop 10
K2_X2:
    s_nop 1
    v_mfma_f32_32x32x16_bf16 v[184:199], v[72:75], v[136:139], v[184:199]
    v_mfma_f32_32x32x16_bf16 v[184:199], v[76:79], v[140:143], v[184:199]
    s_branch K2_P2END
    s_nop 10
K2_X1:
    s_nop 1
    v_mfma_f32_32x32x16_bf16 v[184:199], v[64:67], v[120:123], v[184:199]
    v_mfma_f32_32x32x16_bf16 v[184:199], v[68:71], v[124:127], v[184:199]
    s_branch K2_P2END
    s_nop 10
K3_ENTRY:
    v_lshrrev_b32 v1, 6, v0
    v_and_b32 v2, 63, v0
    v_readfirstlane_b32 s33, v1
    s_and_b32 s20, s2, 7
    s_lshr_b32 s21, s2, 3
    s_cmp_ge_u32 s33, 4
    s_cbranch_scc1 K3_F
    s_load_dwordx2 s[6:7], s[0:1], 16
    s_load_dwordx2 s[4:5], s[0:1], 0
    s_load_dwordx2 s[10:11], s[0:1], 32
    s_load_dwordx2 s[52:53], s[0:1], 64
    s_lshl_b32 s22, s20, 2
    s_lshr_b32 s23, s21, 3
    s_add_u32 s22, s22, s23
    s_and_b32 s23, s21, 7
    s_mov_b32 s25, s33
    s_lshl_b32 s26, s25, 19
    s_lshl_b32 s27, s22, 11
    s_add_u32 s26, s26, s27
    v_lshlrev_b32 v5, 4, v2
    v_add_u32 v5, s26, v5
    v_lshrrev_b32 v6, 3, v2
    v_and_b32 v7, 7, v2
    v_bfe_u32 v8, v6, 1, 1
    v_lshlrev_b32 v8, 2, v8
    v_xor_b32 v7, v7, v8
    v_lshlrev_b32 v7, 4, v7
    v_lshl_add_u32 v6, v6, 10, v7
    s_lshl_b32 s26, s25, 17
    s_lshl_b32 s27, s23, 7
    s_add_u32 s26, s26, s27
    v_add_u32 v6, s26, v6
    s_mul_i32 s31, s25, 17408
    s_waitcnt lgkmcnt(0)
    s_mov_b32 s16, s6
    s_mov_b32 s17, s7
    s_mov_b32 s18, 0x00080000
    s_mov_b32 s19, 0x00020000
    s_add_u32 s36, s8, 0x00600000
    s_addc_u32 s37, s9, 0
    s_mov_b32 s38, 0x00200000
    s_mov_b32 s39, 0x00020000
    s_mov_b32 s12, s4
    s_mov_b32 s13, s5
    s_mov_b32 s14, 0x00200000
    s_mov_b32 s15, 0x00020000
    s_add_u32 s44, s8, 0x00a00000
    s_addc_u32 s45, s9, 0
    s_mov_b32 s46, 0x000b6600
    s_mov_b32 s47, 0x00020000
    s_mov_b32 s48, s10
    s_mov_b32 s49, s11
    s_mov_b32 s50, 0x00000400
    s_mov_b32 s51, 0x00020000
    s_mov_b32 s56, s52
    s_mov_b32 s57, s53
    s_mov_b32 s58, 0x00200000
    s_mov_b32 s59, 0x00020000
    v_lshrrev_b32 v3, 5, v2
    v_and_b32 v4, 31, v2
    v_lshrrev_b32 v9, 2, v0
    v_and_b32 v10, 3, v0
    s_lshl_b32 s26, s22, 16
    s_add_u32 s26, s26, s27
    v_lshlrev_b32 v12, 4, v10
    v_lshl_add_u32 v11, v9, 10, v12
    v_add_u32 v11, s26, v11
    v_add_u32 v12, s27, v12
    v_and_b32 v7, 15, v2
    v_lshrrev_b32 v8, 2, v7
    v_lshl_add_u32 v8, v3, 2, v8
    v_lshlrev_b32 v8, 7, v8
    v_and_b32 v13, 3, v7
    v_lshlrev_b32 v13, 3, v13
    v_bfe_u32 v14, v2, 4, 1
    v_lshl_add_u32 v13, v14, 5, v13
    v_bfe_u32 v14, v7, 3, 1
    v_lshl_add_u32 v13, v14, 6, v13
    v_add3_u32 v7, v8, v13, s31
    v_xor_b32 v8, 64, v7
    v_mul_u32_u24 v13, 272, v4
    v_lshl_add_u32 v13, v3, 4, v13
    v_add_u32 v13, s31, v13
    v_mul_u32_u24 v14, 272, v9
    v_lshl_add_u32 v14, v10, 6, v14
    buffer_load_dwordx4 v[128:131], v11, s[12:15], 0 offen
    buffer_load_dwordx4 v[132:135], v11, s[12:15], 0 offen offset:64
    buffer_load_dwordx4 v[136:139], v12, s[48:51], 0 offen
    buffer_load_dwordx4 v[140:143], v12, s[48:51], 0 offen offset:64
    s_mov_b32 s60, 65536
    s_mov_b32 s61, 131072
    s_mov_b32 s62, 196608
    s_mov_b32 s63, 262144
    s_mov_b32 s64, 327680
    s_mov_b32 s65, 393216
    s_mov_b32 s66, 458752
    s_mov_b32 s35, 400000
    s_waitcnt lgkmcnt(0)
    s_barrier
    ds_read_b64_tr_b16 v[16:17], v7 offset:0
    ds_read_b64_tr_b16 v[18:19], v7 offset:1024
    ds_read_b64_tr_b16 v[20:21], v8 offset:0
    ds_read_b64_tr_b16 v[22:23], v8 offset:1024
    ds_read_b64_tr_b16 v[24:25], v7 offset:2048
    ds_read_b64_tr_b16 v[26:27], v7 offset:3072
    ds_read_b64_tr_b16 v[28:29], v8 offset:2048
    ds_read_b64_tr_b16 v[30:31], v8 offset:3072
    ds_read_b64_tr_b16 v[32:33], v7 offset:4096
    ds_read_b64_tr_b16 v[34:35], v7 offset:5120
    ds_read_b64_tr_b16 v[36:37], v8 offset:4096
    ds_read_b64_tr_b16 v[38:39], v8 offset:5120
    ds_read_b64_tr_b16 v[40:41], v7 offset:6144
    ds_read_b64_tr_b16 v[42:43], v7 offset:7168
    ds_read_b64_tr_b16 v[44:45], v8 offset:6144
    ds_read_b64_tr_b16 v[46:47], v8 offset:7168
    ds_read_b64_tr_b16 v[48:49], v7 offset:8192
    ds_read_b64_tr_b16 v[50:51], v7 offset:9216
    ds_read_b64_tr_b16 v[52:53], v8 offset:8192
    ds_read_b64_tr_b16 v[54:55], v8 offset:9216
    ds_read_b64_tr_b16 v[56:57], v7 offset:10240
    ds_read_b64_tr_b16 v[58:59], v7 offset:11264
    ds_read_b64_tr_b16 v[60:61], v8 offset:10240
    ds_read_b64_tr_b16 v[62:63], v8 offset:11264
    ds_read_b64_tr_b16 v[224:225], v7 offset:12288
    ds_read_b64_tr_b16 v[226:227], v7 offset:13312
    ds_read_b64_tr_b16 v[228:229], v8 offset:12288
    ds_read_b64_tr_b16 v[230:231], v8 offset:13312
    ds_read_b64_tr_b16 v[232:233], v7 offset:14336
    ds_read_b64_tr_b16 v[234:235], v7 offset:15360
    ds_read_b64_tr_b16 v[236:237], v8 offset:14336
    ds_read_b64_tr_b16 v[238:239], v8 offset:15360
    buffer_load_dwordx4 v[160:163], v5, s[36:39], 0 offen offset:0 sc1
    buffer_load_dwordx4 v[164:167], v5, s[36:39], 0 offen offset:1024 sc1
    buffer_load_dwordx4 v[168:171], v5, s[36:39], s60 offen offset:0 sc1
    buffer_load_dwordx4 v[172:175], v5, s[36:39], s60 offen offset:1024 sc1
    buffer_load_dwordx4 v[176:179], v5, s[36:39], s61 offen offset:0 sc1
    buffer_load_dwordx4 v[180:183], v5, s[36:39], s61 offen offset:1024 sc1
    buffer_load_dwordx4 v[184:187], v5, s[36:39], s62 offen offset:0 sc1
    buffer_load_dwordx4 v[188:191], v5, s[36:39], s62 offen offset:1024 sc1
    buffer_load_dwordx4 v[192:195], v5, s[36:39], s63 offen offset:0 sc1
    buffer_load_dwordx4 v[196:199], v5, s[36:39], s63 offen offset:1024 sc1
    buffer_load_dwordx4 v[200:203], v5, s[36:39], s64 offen offset:0 sc1
    buffer_load_dwordx4 v[204:207], v5, s[36:39], s64 offen offset:1024 sc1
    buffer_load_dwordx4 v[208:211], v5, s[36:39], s65 offen offset:0 sc1
    buffer_load_dwordx4 v[212:215], v5, s[36:39], s65 offen offset:1024 sc1
    buffer_load_dwordx4 v[216:219], v5, s[36:39], s66 offen offset:0 sc1
    buffer_load_dwordx4 v[220:223], v5, s[36:39], s66 offen offset:1024 sc1
    s_waitcnt lgkmcnt(0)
    s_nop 0
K3_OC0:
    s_waitcnt vmcnt(14)
    v_max3_u32 v1, v160, v161, v162
    v_max3_u32 v3, v163, v164, v165
    v_max3_u32 v1, v1, v166, v167
    v_max_u32 v1, v1, v3
    v_cmp_eq_u32 vcc, -1, v1
    s_nop 4
    s_cbranch_vccnz K3_OR0
K3_OK0:
    v_mfma_f32_32x32x16_bf16 v[64:79], v[16:19], v[160:163], 0
    v_mfma_f32_32x32x16_bf16 v[80:95], v[16:19], v[164:167], 0
    v_mfma_f32_32x32x16_bf16 v[96:111], v[20:23], v[160:163], 0
    v_mfma_f32_32x32x16_bf16 v[112:127], v[20:23], v[164:167], 0
    s_nop 11
K3_OC1:
    s_waitcnt vmcnt(12)
    v_max3_u32 v1, v168, v169, v170
    v_max3_u32 v3, v171, v172, v173
    v_max3_u32 v1, v1, v174, v175
    v_max_u32 v1, v1, v3
    v_cmp_eq_u32 vcc, -1, v1
    s_nop 4
    s_cbranch_vccnz K3_OR1
K3_OK1:
    v_mfma_f32_32x32x16_bf16 v[64:79], v[24:27], v[168:171], v[64:79]
    v_mfma_f32_32x32x16_bf16 v[80:95], v[24:27], v[172:175], v[80:95]
    v_mfma_f32_32x32x16_bf16 v[96:111], v[28:31], v[168:171], v[96:111]
    v_mfma_f32_32x32x16_bf16 v[112:127], v[28:31], v[172:175], v[112:127]
    s_nop 11
K3_OC2:
    s_waitcnt vmcnt(10)
    v_max3_u32 v1, v176, v177, v178
    v_max3_u32 v3, v179, v180, v181
    v_max3_u32 v1, v1, v182, v183
    v_max_u32 v1, v1, v3
    v_cmp_eq_u32 vcc, -1, v1
    s_nop 4
    s_cbranch_vccnz K3_OR2
K3_OK2:
    v_mfma_f32_32x32x16_bf16 v[64:79], v[32:35], v[176:179], v[64:79]
    v_mfma_f32_32x32x16_bf16 v[80:95], v[32:35], v[180:183], v[80:95]
    v_mfma_f32_32x32x16_bf16 v[96:111], v[36:39], v[176:179], v[96:111]
    v_mfma_f32_32x32x16_bf16 v[112:127], v[36:39], v[180:183], v[112:127]
    s_nop 11
K3_OC3:
    s_waitcnt vmcnt(8)
    v_max3_u32 v1, v184, v185, v186
    v_max3_u32 v3, v187, v188, v189
    v_max3_u32 v1, v1, v190, v191
    v_max_u32 v1, v1, v3
    v_cmp_eq_u32 vcc, -1, v1
    s_nop 4
    s_cbranch_vccnz K3_OR3
K3_OK3:
    v_mfma_f32_32x32x16_bf16 v[64:79], v[40:43], v[184:187], v[64:79]
    v_mfma_f32_32x32x16_bf16 v[80:95], v[40:43], v[188:191], v[80:95]
    v_mfma_f32_32x32x16_bf16 v[96:111], v[44:47], v[184:187], v[96:111]
    v_mfma_f32_32x32x16_bf16 v[112:127], v[44:47], v[188:191], v[112:127]
    s_nop 11
K3_OC4:
    s_waitcnt vmcnt(6)
    v_max3_u32 v1, v192, v193, v194
    v_max3_u32 v3, v195, v196, v197
    v_max3_u32 v1, v1, v198, v199
    v_max_u32 v1, v1, v3
    v_cmp_eq_u32 vcc, -1, v1
    s_nop 4
    s_cbranch_vccnz K3_OR4
K3_OK4:
    v_mfma_f32_32x32x16_bf16 v[64:79], v[48:51], v[192:195], v[64:79]
    v_mfma_f32_32x32x16_bf16 v[80:95], v[48:51], v[196:199], v[80:95]
    v_mfma_f32_32x32x16_bf16 v[96:111], v[52:55], v[192:195], v[96:111]
    v_mfma_f32_32x32x16_bf16 v[112:127], v[52:55], v[196:199], v[112:127]
    s_nop 11
K3_OC5:
    s_waitcnt vmcnt(4)
    v_max3_u32 v1, v200, v201, v202
    v_max3_u32 v3, v203, v204, v205
    v_max3_u32 v1, v1, v206, v207
    v_max_u32 v1, v1, v3
    v_cmp_eq_u32 vcc, -1, v1
    s_nop 4
    s_cbranch_vccnz K3_OR5
K3_OK5:
    v_mfma_f32_32x32x16_bf16 v[64:79], v[56:59], v[200:203], v[64:79]
    v_mfma_f32_32x32x16_bf16 v[80:95], v[56:59], v[204:207], v[80:95]
    v_mfma_f32_32x32x16_bf16 v[96:111], v[60:63], v[200:203], v[96:111]
    v_mfma_f32_32x32x16_bf16 v[112:127], v[60:63], v[204:207], v[112:127]
    s_nop 11
K3_OC6:
    s_waitcnt vmcnt(2)
    v_max3_u32 v1, v208, v209, v210
    v_max3_u32 v3, v211, v212, v213
    v_max3_u32 v1, v1, v214, v215
    v_max_u32 v1, v1, v3
    v_cmp_eq_u32 vcc, -1, v1
    s_nop 4
    s_cbranch_vccnz K3_OR6
K3_OK6:
K3_OC7:
    s_waitcnt vmcnt(0)
    v_max3_u32 v1, v216, v217, v218
    v_max3_u32 v3, v219, v220, v221
    v_max3_u32 v1, v1, v222, v223
    v_max_u32 v1, v1, v3
    v_cmp_eq_u32 vcc, -1, v1
    s_nop 4
    s_cbranch_vccnz K3_OR7
K3_OK7:
    v_mfma_f32_32x32x16_bf16 v[64:79], v[224:227], v[208:211], v[64:79]
    v_mfma_f32_32x32x16_bf16 v[80:95], v[224:227], v[212:215], v[80:95]
    v_mfma_f32_32x32x16_bf16 v[64:79], v[232:235], v[216:219], v[64:79]
    v_mfma_f32_32x32x16_bf16 v[80:95], v[232:235], v[220:223], v[80:95]
    v_mfma_f32_32x32x16_bf16 v[96:111], v[228:231], v[208:211], v[96:111]
    v_lshlrev_b32 v144, 16, v128
    v_lshlrev_b32 v146, 16, v129
    v_lshlrev_b32 v148, 16, v130
    v_lshlrev_b32 v150, 16, v131
    v_lshlrev_b32 v152, 16, v132
    v_lshlrev_b32 v154, 16, v133
    v_lshlrev_b32 v156, 16, v134
    v_lshlrev_b32 v158, 16, v135
    v_mfma_f32_32x32x16_bf16 v[96:111], v[236:239], v[216:219], v[96:111]
    s_nop 0
    ds_write_b128 v13, v[64:67] offset:0
    ds_write_b128 v13, v[68:71] offset:64
    ds_write_b128 v13, v[72:75] offset:128
    ds_write_b128 v13, v[76:79] offset:192
    v_mfma_f32_32x32x16_bf16 v[112:127], v[228:231], v[212:215], v[112:127]
    ds_write_b128 v13, v[80:83] offset:8704
    ds_write_b128 v13, v[84:87] offset:8768
    ds_write_b128 v13, v[88:91] offset:8832
    ds_write_b128 v13, v[92:95] offset:8896
    v_mfma_f32_32x32x16_bf16 v[112:127], v[236:239], v[220:223], v[112:127]
    v_and_b32 v145, 0xffff0000, v128
    v_and_b32 v147, 0xffff0000, v129
    v_and_b32 v149, 0xffff0000, v130
    v_and_b32 v151, 0xffff0000, v131
    v_and_b32 v153, 0xffff0000, v132
    v_and_b32 v155, 0xffff0000, v133
    v_and_b32 v157, 0xffff0000, v134
    v_and_b32 v159, 0xffff0000, v135
    ds_write_b128 v13, v[96:99] offset:32
    ds_write_b128 v13, v[100:103] offset:96
    ds_write_b128 v13, v[104:107] offset:160
    ds_write_b128 v13, v[108:111] offset:224
    ds_write_b128 v13, v[112:115] offset:8736
    ds_write_b128 v13, v[116:119] offset:8800
    ds_write_b128 v13, v[120:123] offset:8864
    ds_write_b128 v13, v[124:127] offset:8928
    v_mov_b32 v15, 0x3f803f80
    s_lshl_b32 s26, s22, 6
    v_add_u32 v4, s26, v9
    s_lshl_b32 s26, s22, 13
    v_lshlrev_b32 v1, 4, v9
    v_add_u32 v1, s26, v1
    s_lshl_b32 s28, s23, 10
    s_add_u32 s29, s28, 331776
    s_mov_b32 s24, 331776
    v_lshl_add_u32 v3, v10, 11, v1
    s_movk_i32 s30, 0xf800
    v_mov_b32 v52, 0x3b000000
    v_mov_b32 v53, 0x3727c5ac
    s_lshl_b32 s34, s25, 3
    s_add_u32 s34, s34, 69632
    v_mov_b32 v54, s34
    v_mov_b32 v55, 69632
    s_waitcnt lgkmcnt(0)
    s_barrier
    ds_read_b128 v[64:67], v14 offset:0
    ds_read_b128 v[68:71], v14 offset:16
    ds_read_b128 v[72:75], v14 offset:32
    ds_read_b128 v[76:79], v14 offset:48
    ds_read_b128 v[80:83], v14 offset:17408
    ds_read_b128 v[84:87], v14 offset:17424
    ds_read_b128 v[88:91], v14 offset:17440
    ds_read_b128 v[92:95], v14 offset:17456
    ds_read_b128 v[96:99], v14 offset:34816
    ds_read_b128 v[100:103], v14 offset:34832
    ds_read_b128 v[104:107], v14 offset:34848
    ds_read_b128 v[108:111], v14 offset:34864
    ds_read_b128 v[112:115], v14 offset:52224
    ds_read_b128 v[116:119], v14 offset:52240
    ds_read_b128 v[120:123], v14 offset:52256
    ds_read_b128 v[124:127], v14 offset:52272
    ds_read_b32 v13, v55 offset:48
    s_waitcnt lgkmcnt(13)
    v_pk_add_f32 v[32:33], v[144:145], v[64:65]
    v_pk_add_f32 v[34:35], v[146:147], v[66:67]
    v_pk_add_f32 v[36:37], v[148:149], v[68:69]
    v_pk_add_f32 v[38:39], v[150:151], v[70:71]
    v_pk_add_f32 v[40:41], v[152:153], v[72:73]
    v_pk_add_f32 v[42:43], v[154:155], v[74:75]
    v_pk_add_f32 v[44:45], v[156:157], v[76:77]
    v_pk_add_f32 v[46:47], v[158:159], v[78:79]
    s_waitcnt lgkmcnt(5)
    v_pk_add_f32 v[80:81], v[80:81], v[96:97]
    v_pk_add_f32 v[82:83], v[82:83], v[98:99]
    v_pk_add_f32 v[84:85], v[84:85], v[100:101]
    v_pk_add_f32 v[86:87], v[86:87], v[102:103]
    v_pk_add_f32 v[88:89], v[88:89], v[104:105]
    v_pk_add_f32 v[90:91], v[90:91], v[106:107]
    v_pk_add_f32 v[92:93], v[92:93], v[108:109]
    v_pk_add_f32 v[94:95], v[94:95], v[110:111]
    s_waitcnt lgkmcnt(0)
    v_pk_add_f32 v[32:33], v[32:33], v[112:113]
    v_pk_add_f32 v[34:35], v[34:35], v[114:115]
    v_pk_add_f32 v[36:37], v[36:37], v[116:117]
    v_pk_add_f32 v[38:39], v[38:39], v[118:119]
    v_pk_add_f32 v[40:41], v[40:41], v[120:121]
    v_pk_add_f32 v[42:43], v[42:43], v[122:123]
    v_pk_add_f32 v[44:45], v[44:45], v[124:125]
    v_pk_add_f32 v[46:47], v[46:47], v[126:127]
    v_pk_add_f32 v[32:33], v[32:33], v[80:81]
    v_pk_add_f32 v[34:35], v[34:35], v[82:83]
    v_pk_add_f32 v[36:37], v[36:37], v[84:85]
    v_pk_add_f32 v[38:39], v[38:39], v[86:87]
    v_pk_add_f32 v[40:41], v[40:41], v[88:89]
    v_pk_add_f32 v[42:43], v[42:43], v[90:91]
    v_pk_add_f32 v[44:45], v[44:45], v[92:93]
    v_pk_add_f32 v[46:47], v[46:47], v[94:95]
    v_cvt_pk_bf16_f32 v16, v32, v33
    v_cvt_pk_bf16_f32 v17, v34, v35
    v_cvt_pk_bf16_f32 v18, v36, v37
    v_cvt_pk_bf16_f32 v19, v38, v39
    v_cvt_pk_bf16_f32 v20, v40, v41
    v_cvt_pk_bf16_f32 v21, v42, v43
    v_cvt_pk_bf16_f32 v22, v44, v45
    v_cvt_pk_bf16_f32 v23, v46, v47
    v_dot2_f32_bf16 v48, v16, v15, 0
    v_dot2_f32_bf16 v49, v16, v16, 0
    v_dot2_f32_bf16 v50, v16, v136, 0
    v_dot2_f32_bf16 v48, v17, v15, v48
    v_dot2_f32_bf16 v49, v17, v17, v49
    v_dot2_f32_bf16 v50, v17, v137, v50
    v_dot2_f32_bf16 v48, v18, v15, v48
    v_dot2_f32_bf16 v49, v18, v18, v49
    v_dot2_f32_bf16 v50, v18, v138, v50
    v_dot2_f32_bf16 v48, v19, v15, v48
    v_dot2_f32_bf16 v49, v19, v19, v49
    v_dot2_f32_bf16 v50, v19, v139, v50
    v_dot2_f32_bf16 v48, v20, v15, v48
    v_dot2_f32_bf16 v49, v20, v20, v49
    v_dot2_f32_bf16 v50, v20, v140, v50
    v_dot2_f32_bf16 v48, v21, v15, v48
    v_dot2_f32_bf16 v49, v21, v21, v49
    v_dot2_f32_bf16 v50, v21, v141, v50
    v_dot2_f32_bf16 v48, v22, v15, v48
    v_dot2_f32_bf16 v49, v22, v22, v49
    v_dot2_f32_bf16 v50, v22, v142, v50
    v_dot2_f32_bf16 v48, v23, v15, v48
    v_dot2_f32_bf16 v49, v23, v23, v49
    v_dot2_f32_bf16 v50, v23, v143, v50
    s_nop 0
    v_add_f32_dpp v48, v48, v48 quad_perm:[1,0,3,2] row_mask:0xf bank_mask:0xf
    v_add_f32_dpp v49, v49, v49 quad_perm:[1,0,3,2] row_mask:0xf bank_mask:0xf
    v_add_f32_dpp v50, v50, v50 quad_perm:[1,0,3,2] row_mask:0xf bank_mask:0xf
    v_add_f32_dpp v48, v48, v48 quad_perm:[2,3,0,1] row_mask:0xf bank_mask:0xf
    v_add_f32_dpp v49, v49, v49 quad_perm:[2,3,0,1] row_mask:0xf bank_mask:0xf
    v_add_f32_dpp v50, v50, v50 quad_perm:[2,3,0,1] row_mask:0xf bank_mask:0xf
    v_min_u32 v76, -2, v48
    v_min_u32 v77, -2, v49
    v_min_u32 v78, -2, v50
    v_mov_b32 v79, 0
    s_mov_b32 exec_lo, 0x11111111
    s_mov_b32 exec_hi, 0x11111111
    buffer_store_dwordx4 v[76:79], v1, s[44:47], s29 offen
    s_mov_b64 exec, -1
    v_lshlrev_b32 v32, 16, v16
    v_and_b32 v33, 0xffff0000, v16
    v_lshlrev_b32 v34, 16, v17
    v_and_b32 v35, 0xffff0000, v17
    v_lshlrev_b32 v36, 16, v18
    v_and_b32 v37, 0xffff0000, v18
    v_lshlrev_b32 v38, 16, v19
    v_and_b32 v39, 0xffff0000, v19
    v_lshlrev_b32 v40, 16, v20
    v_and_b32 v41, 0xffff0000, v20
    v_lshlrev_b32 v42, 16, v21
    v_and_b32 v43, 0xffff0000, v21
    v_lshlrev_b32 v44, 16, v22
    v_and_b32 v45, 0xffff0000, v22
    v_lshlrev_b32 v46, 16, v23
    v_and_b32 v47, 0xffff0000, v23
    v_min_u32 v16, -2, v16
    v_min_u32 v17, -2, v17
    v_min_u32 v18, -2, v18
    v_min_u32 v19, -2, v19
    v_min_u32 v20, -2, v20
    v_min_u32 v21, -2, v21
    v_min_u32 v22, -2, v22
    v_min_u32 v23, -2, v23
    s_mov_b32 s35, 12
    s_nop 3
K3_P1F:
    buffer_load_dwordx4 v[64:67], v3, s[44:47], s24 offen sc1
    buffer_load_dwordx4 v[68:71], v3, s[44:47], s24 offen offset:1024 sc1
    s_sub_u32 s35, s35, 1
    s_waitcnt vmcnt(1)
    v_max3_u32 v72, v64, v65, v66
    s_waitcnt vmcnt(0)
    v_max3_u32 v72, v72, v68, v69
    v_max_u32 v72, v72, v70
    v_cmp_eq_u32 vcc, -1, v72
    s_nop 4
    s_cbranch_vccz K3_P1OK
    s_cmp_lg_u32 s35, 0
    s_cbranch_scc1 K3_P1F
    s_mov_b32 exec_lo, 0x11111111
    s_mov_b32 exec_hi, 0x11111111
    buffer_store_dwordx4 v[76:79], v1, s[44:47], s28 offen sc1
    s_mov_b64 exec, -1
    s_mov_b32 s35, 400000
    s_nop 0
K3_P1:
    buffer_load_dwordx4 v[64:67], v3, s[44:47], 0 offen sc1
    buffer_load_dwordx4 v[68:71], v3, s[44:47], 0 offen offset:1024 sc1
    s_sub_u32 s35, s35, 1
    s_waitcnt vmcnt(1)
    v_max3_u32 v72, v64, v65, v66
    s_waitcnt vmcnt(0)
    v_max3_u32 v72, v72, v68, v69
    v_max_u32 v72, v72, v70
    v_cmp_eq_u32 vcc, -1, v72
    s_cmp_eq_u32 s35, 0
    s_cbranch_scc1 K3_P1X
    s_nop 3
    s_cbranch_vccnz K3_P1
K3_P1X:
K3_P1OK:
    v_add_f32 v64, v64, v68
    v_add_f32 v65, v65, v69
    v_add_f32 v66, v66, v70
    v_add_f32_dpp v64, v64, v64 quad_perm:[1,0,3,2] row_mask:0xf bank_mask:0xf
    v_add_f32_dpp v65, v65, v65 quad_perm:[1,0,3,2] row_mask:0xf bank_mask:0xf
    v_add_f32_dpp v66, v66, v66 quad_perm:[1,0,3,2] row_mask:0xf bank_mask:0xf
    v_add_f32_dpp v64, v64, v64 quad_perm:[2,3,0,1] row_mask:0xf bank_mask:0xf
    v_add_f32_dpp v65, v65, v65 quad_perm:[2,3,0,1] row_mask:0xf bank_mask:0xf
    v_add_f32_dpp v66, v66, v66 quad_perm:[2,3,0,1] row_mask:0xf bank_mask:0xf
    v_mul_f32 v69, v52, v64
    v_fma_f32 v70, v65, v52, v53
    v_fma_f32 v70, -v69, v69, v70
    v_max_f32 v70, v53, v70
    v_rsq_f32 v70, v70
    v_fma_f32 v71, -v69, v13, v66
    v_mul_f32 v71, v71, v70
    v_and_or_b32 v68, v71, s30, v4
    v_mov_b32 v5, v68
    v_mov_b32 v6, 0xff7fffff
    s_nop 0
    v_mov_b32_dpp v7, v5 row_ror:4 row_mask:0xf bank_mask:0xf
    v_mov_b32_dpp v8, v6 row_ror:4 row_mask:0xf bank_mask:0xf
    v_min_f32 v9, v5, v7
    v_max_f32 v5, v5, v7
    v_max3_f32 v6, v6, v8, v9
    s_nop 0
    v_mov_b32_dpp v7, v5 row_ror:8 row_mask:0xf bank_mask:0xf
    v_mov_b32_dpp v8, v6 row_ror:8 row_mask:0xf bank_mask:0xf
    v_min_f32 v9, v5, v7
    v_max_f32 v5, v5, v7
    v_max3_f32 v6, v6, v8, v9
    v_mov_b32 v7, v5
    v_mov_b32 v8, v6
    s_nop 0
    v_permlane16_swap_b32 v5, v7
    v_permlane16_swap_b32 v6, v8
    v_min_f32 v9, v5, v7
    v_max_f32 v5, v5, v7
    v_max3_f32 v6, v6, v8, v9
    v_mov_b32 v7, v5
    v_mov_b32 v8, v6
    s_nop 0
    v_permlane32_swap_b32 v5, v7
    v_permlane32_swap_b32 v6, v8
    v_min_f32 v9, v5, v7
    v_max_f32 v5, v5, v7
    v_max3_f32 v6, v6, v8, v9
    ds_write2_b32 v54, v5, v6 offset0:0 offset1:1
    v_mul_f32 v50, v69, v70
    v_add_f32 v51, 1.0, v70
    v_min_u32 v72, -2, v68
    v_min_u32 v73, -2, v69
    v_min_u32 v74, -2, v70
    v_min_u32 v75, -2, v71
    s_lshl_b32 s26, s22, 11
    s_add_u32 s26, s26, 262144
    v_add_u32 v12, s26, v12
    s_lshl_b32 s26, s22, 7
    s_add_u32 s26, s26, 327680
    s_mov_b32 exec_lo, 0x11111111
    s_mov_b32 exec_hi, 0x11111111
    buffer_store_dwordx4 v[76:79], v1, s[44:47], s28 offen sc1
    s_mov_b64 exec, -1
    s_waitcnt lgkmcnt(0)
    s_barrier
    ds_read_b128 v[56:59], v55
    ds_read_b128 v[60:63], v55 offset:16
    s_waitcnt lgkmcnt(0)
    v_min_f32 v7, v56, v58
    v_max_f32 v56, v56, v58
    v_max3_f32 v57, v57, v59, v7
    v_min_f32 v7, v60, v62
    v_max_f32 v60, v60, v62
    v_max3_f32 v61, v61, v63, v7
    v_min_f32 v7, v56, v60
    v_max_f32 v56, v56, v60
    v_max3_f32 v57, v57, v61, v7
    v_cmp_eq_u32 s[40:41], v68, v56
    v_cmp_eq_u32 s[42:43], v68, v57
    v_mov_b32 v7, 0
    s_nop 0
    v_cndmask_b32 v7, 0, 1, s[42:43]
    s_or_b64 s[40:41], s[40:41], s[42:43]
    v_lshl_add_u32 v12, v7, 10, v12
    v_lshlrev_b32 v7, 4, v7
    s_mov_b64 exec, s[40:41]
    s_cbranch_execz K3_NOCAND
    buffer_store_dwordx4 v[16:19], v12, s[44:47], 0 offen sc1
    buffer_store_dwordx4 v[20:23], v12, s[44:47], 0 offen offset:64 sc1
    s_cmp_lg_u32 s23, 0
    s_cbranch_scc1 K3_NOGRN
    s_and_b32 exec_lo, exec_lo, 0x11111111
    s_and_b32 exec_hi, exec_hi, 0x11111111
    buffer_store_dwordx4 v[72:75], v7, s[44:47], s26 offen sc1
    s_mov_b64 exec, s[40:41]
K3_NOGRN:
    s_nop 0
K3_NOCAND:
    s_mov_b64 exec, -1
    v_fma_f32 v32, v32, v51, -v50
    v_fma_f32 v33, v33, v51, -v50
    v_fma_f32 v34, v34, v51, -v50
    v_fma_f32 v35, v35, v51, -v50
    v_fma_f32 v36, v36, v51, -v50
    v_fma_f32 v37, v37, v51, -v50
    v_fma_f32 v38, v38, v51, -v50
    v_fma_f32 v39, v39, v51, -v50
    v_fma_f32 v40, v40, v51, -v50
    v_fma_f32 v41, v41, v51, -v50
    v_fma_f32 v42, v42, v51, -v50
    v_fma_f32 v43, v43, v51, -v50
    v_fma_f32 v44, v44, v51, -v50
    v_fma_f32 v45, v45, v51, -v50
    v_fma_f32 v46, v46, v51, -v50
    v_fma_f32 v47, v47, v51, -v50
    v_cvt_pk_bf16_f32 v24, v32, v33
    v_cvt_pk_bf16_f32 v25, v34, v35
    v_cvt_pk_bf16_f32 v26, v36, v37
    v_cvt_pk_bf16_f32 v27, v38, v39
    v_cvt_pk_bf16_f32 v28, v40, v41
    v_cvt_pk_bf16_f32 v29, v42, v43
    v_cvt_pk_bf16_f32 v30, v44, v45
    v_cvt_pk_bf16_f32 v31, v46, v47
    s_barrier
    ds_read_b32 v56, v55 offset:1088
    ds_read_b32 v57, v55 offset:1104
    s_waitcnt lgkmcnt(0)
    v_cmp_ne_u32 vcc, v68, v56
    v_cmp_ne_u32 s[42:43], v68, v57
    s_nop 0
    s_and_b64 exec, vcc, s[42:43]
    buffer_store_dwordx4 v[24:27], v11, s[56:59], 0 offen sc1
    buffer_store_dwordx4 v[28:31], v11, s[56:59], 0 offen offset:64 sc1
    s_endpgm
    s_nop 0
K3_OR0:
    s_sub_u32 s35, s35, 1
    s_cmp_eq_u32 s35, 0
    s_cbranch_scc1 K3_OK0
    s_sleep 1
    buffer_load_dwordx4 v[160:163], v5, s[36:39], 0 offen offset:0 sc1
    buffer_load_dwordx4 v[164:167], v5, s[36:39], 0 offen offset:1024 sc1
    buffer_load_dwordx4 v[168:171], v5, s[36:39], s60 offen offset:0 sc1
    buffer_load_dwordx4 v[172:175], v5, s[36:39], s60 offen offset:1024 sc1
    buffer_load_dwordx4 v[176:179], v5, s[36:39], s61 offen offset:0 sc1
    buffer_load_dwordx4 v[180:183], v5, s[36:39], s61 offen offset:1024 sc1
    buffer_load_dwordx4 v[184:187], v5, s[36:39], s62 offen offset:0 sc1
    buffer_load_dwordx4 v[188:191], v5, s[36:39], s62 offen offset:1024 sc1
    buffer_load_dwordx4 v[192:195], v5, s[36:39], s63 offen offset:0 sc1
    buffer_load_dwordx4 v[196:199], v5, s[36:39], s63 offen offset:1024 sc1
    buffer_load_dwordx4 v[200:203], v5, s[36:39], s64 offen offset:0 sc1
    buffer_load_dwordx4 v[204:207], v5, s[36:39], s64 offen offset:1024 sc1
    buffer_load_dwordx4 v[208:211], v5, s[36:39], s65 offen offset:0 sc1
    buffer_load_dwordx4 v[212:215], v5, s[36:39], s65 offen offset:1024 sc1
    buffer_load_dwordx4 v[216:219], v5, s[36:39], s66 offen offset:0 sc1
    buffer_load_dwordx4 v[220:223], v5, s[36:39], s66 offen offset:1024 sc1
    s_branch K3_OC0
    s_nop 0
K3_OR1:
    s_sub_u32 s35, s35, 1
    s_cmp_eq_u32 s35, 0
    s_cbranch_scc1 K3_OK1
    s_sleep 1
    buffer_load_dwordx4 v[168:171], v5, s[36:39], s60 offen offset:0 sc1
    buffer_load_dwordx4 v[172:175], v5, s[36:39], s60 offen offset:1024 sc1
    buffer_load_dwordx4 v[176:179], v5, s[36:39], s61 offen offset:0 sc1
    buffer_load_dwordx4 v[180:183], v5, s[36:39], s61 offen offset:1024 sc1
    buffer_load_dwordx4 v[184:187], v5, s[36:39], s62 offen offset:0 sc1
    buffer_load_dwordx4 v[188:191], v5, s[36:39], s62 offen offset:1024 sc1
    buffer_load_dwordx4 v[192:195], v5, s[36:39], s63 offen offset:0 sc1
    buffer_load_dwordx4 v[196:199], v5, s[36:39], s63 offen offset:1024 sc1
    buffer_load_dwordx4 v[200:203], v5, s[36:39], s64 offen offset:0 sc1
    buffer_load_dwordx4 v[204:207], v5, s[36:39], s64 offen offset:1024 sc1
    buffer_load_dwordx4 v[208:211], v5, s[36:39], s65 offen offset:0 sc1
    buffer_load_dwordx4 v[212:215], v5, s[36:39], s65 offen offset:1024 sc1
    buffer_load_dwordx4 v[216:219], v5, s[36:39], s66 offen offset:0 sc1
    buffer_load_dwordx4 v[220:223], v5, s[36:39], s66 offen offset:1024 sc1
    s_branch K3_OC1
    s_nop 0
K3_OR2:
    s_sub_u32 s35, s35, 1
    s_cmp_eq_u32 s35, 0
    s_cbranch_scc1 K3_OK2
    s_sleep 1
    buffer_load_dwordx4 v[176:179], v5, s[36:39], s61 offen offset:0 sc1
    buffer_load_dwordx4 v[180:183], v5, s[36:39], s61 offen offset:1024 sc1
    buffer_load_dwordx4 v[184:187], v5, s[36:39], s62 offen offset:0 sc1
    buffer_load_dwordx4 v[188:191], v5, s[36:39], s62 offen offset:1024 sc1
    buffer_load_dwordx4 v[192:195], v5, s[36:39], s63 offen offset:0 sc1
    buffer_load_dwordx4 v[196:199], v5, s[36:39], s63 offen offset:1024 sc1
    buffer_load_dwordx4 v[200:203], v5, s[36:39], s64 offen offset:0 sc1
    buffer_load_dwordx4 v[204:207], v5, s[36:39], s64 offen offset:1024 sc1
    buffer_load_dwordx4 v[208:211], v5, s[36:39], s65 offen offset:0 sc1
    buffer_load_dwordx4 v[212:215], v5, s[36:39], s65 offen offset:1024 sc1
    buffer_load_dwordx4 v[216:219], v5, s[36:39], s66 offen offset:0 sc1
    buffer_load_dwordx4 v[220:223], v5, s[36:39], s66 offen offset:1024 sc1
    s_branch K3_OC2
    s_nop 0
K3_OR3:
    s_sub_u32 s35, s35, 1
    s_cmp_eq_u32 s35, 0
    s_cbranch_scc1 K3_OK3
    s_sleep 1
    buffer_load_dwordx4 v[184:187], v5, s[36:39], s62 offen offset:0 sc1
    buffer_load_dwordx4 v[188:191], v5, s[36:39], s62 offen offset:1024 sc1
    buffer_load_dwordx4 v[192:195], v5, s[36:39], s63 offen offset:0 sc1
    buffer_load_dwordx4 v[196:199], v5, s[36:39], s63 offen offset:1024 sc1
    buffer_load_dwordx4 v[200:203], v5, s[36:39], s64 offen offset:0 sc1
    buffer_load_dwordx4 v[204:207], v5, s[36:39], s64 offen offset:1024 sc1
    buffer_load_dwordx4 v[208:211], v5, s[36:39], s65 offen offset:0 sc1
    buffer_load_dwordx4 v[212:215], v5, s[36:39], s65 offen offset:1024 sc1
    buffer_load_dwordx4 v[216:219], v5, s[36:39], s66 offen offset:0 sc1
    buffer_load_dwordx4 v[220:223], v5, s[36:39], s66 offen offset:1024 sc1
    s_branch K3_OC3
    s_nop 0
K3_OR4:
    s_sub_u32 s35, s35, 1
    s_cmp_eq_u32 s35, 0
    s_cbranch_scc1 K3_OK4
    s_sleep 1
    buffer_load_dwordx4 v[192:195], v5, s[36:39], s63 offen offset:0 sc1
    buffer_load_dwordx4 v[196:199], v5, s[36:39], s63 offen offset:1024 sc1
    buffer_load_dwordx4 v[200:203], v5, s[36:39], s64 offen offset:0 sc1
    buffer_load_dwordx4 v[204:207], v5, s[36:39], s64 offen offset:1024 sc1
    buffer_load_dwordx4 v[208:211], v5, s[36:39], s65 offen offset:0 sc1
    buffer_load_dwordx4 v[212:215], v5, s[36:39], s65 offen offset:1024 sc1
    buffer_load_dwordx4 v[216:219], v5, s[36:39], s66 offen offset:0 sc1
    buffer_load_dwordx4 v[220:223], v5, s[36:39], s66 offen offset:1024 sc1
    s_branch K3_OC4
    s_nop 0
K3_OR5:
    s_sub_u32 s35, s35, 1
    s_cmp_eq_u32 s35, 0
    s_cbranch_scc1 K3_OK5
    s_sleep 1
    buffer_load_dwordx4 v[200:203], v5, s[36:39], s64 offen offset:0 sc1
    buffer_load_dwordx4 v[204:207], v5, s[36:39], s64 offen offset:1024 sc1
    buffer_load_dwordx4 v[208:211], v5, s[36:39], s65 offen offset:0 sc1
    buffer_load_dwordx4 v[212:215], v5, s[36:39], s65 offen offset:1024 sc1
    buffer_load_dwordx4 v[216:219], v5, s[36:39], s66 offen offset:0 sc1
    buffer_load_dwordx4 v[220:223], v5, s[36:39], s66 offen offset:1024 sc1
    s_branch K3_OC5
    s_nop 0
K3_OR6:
    s_sub_u32 s35, s35, 1
    s_cmp_eq_u32 s35, 0
    s_cbranch_scc1 K3_OK6
    s_sleep 1
    buffer_load_dwordx4 v[208:211], v5, s[36:39], s65 offen offset:0 sc1
    buffer_load_dwordx4 v[212:215], v5, s[36:39], s65 offen offset:1024 sc1
    buffer_load_dwordx4 v[216:219], v5, s[36:39], s66 offen offset:0 sc1
    buffer_load_dwordx4 v[220:223], v5, s[36:39], s66 offen offset:1024 sc1
    s_branch K3_OC6
    s_nop 0
K3_OR7:
    s_sub_u32 s35, s35, 1
    s_cmp_eq_u32 s35, 0
    s_cbranch_scc1 K3_OK7
    s_sleep 1
    buffer_load_dwordx4 v[216:219], v5, s[36:39], s66 offen offset:0 sc1
    buffer_load_dwordx4 v[220:223], v5, s[36:39], s66 offen offset:1024 sc1
    s_branch K3_OC7
    s_nop 0
K3_F:
    s_load_dwordx4 s[4:7], s[0:1], 32
    s_load_dwordx4 s[12:15], s[0:1], 48
    s_load_dwordx2 s[10:11], s[0:1], 64
    s_sub_u32 s25, s33, 4
    s_mul_i32 s22, s20, 22
    s_add_u32 s22, s22, s21
    s_lshl_b32 s23, s20, 2
    s_add_u32 s23, s23, s21
    s_sub_u32 s23, s23, 22
    s_lshl_b32 s23, s23, 1
    s_cmp_lt_u32 s22, 172
    s_cselect_b32 s24, 1, 0
    s_cmp_lt_u32 s21, 22
    s_cselect_b32 s24, s24, 2
    s_cselect_b32 s26, s22, s23
    s_cmp_lt_u32 s21, 26
    s_cselect_b32 s24, s24, 0
    s_lshl_b32 s26, s26, 4
    s_cmp_eq_u32 s24, 2
    s_cselect_b32 s27, 0, s25
    s_cmp_lg_u32 s27, 0
    s_cbranch_scc1 K3_END
    s_barrier
    v_lshlrev_b32 v4, 4, v2
    s_waitcnt lgkmcnt(0)
    s_mov_b32 s16, s4
    s_mov_b32 s17, s5
    s_mov_b32 s18, 0x00000400
    s_mov_b32 s19, 0x00020000
    s_mov_b32 s28, s6
    s_mov_b32 s29, s7
    s_mov_b32 s30, 0x00158000
    s_mov_b32 s31, 0x00020000
    s_mov_b32 s36, s12
    s_mov_b32 s37, s13
    s_mov_b32 s38, 0x00158000
    s_mov_b32 s39, 0x00020000
    s_mov_b32 s40, s14
    s_mov_b32 s41, s15
    s_mov_b32 s42, 0x00158000
    s_mov_b32 s43, 0x00020000
    s_add_u32 s44, s8, 0x00a00000
    s_addc_u32 s45, s9, 0
    s_mov_b32 s46, 0x000b6600
    s_mov_b32 s47, 0x00020000
    s_mov_b32 s52, s10
    s_mov_b32 s53, s11
    s_mov_b32 s54, 0x00200000
    s_mov_b32 s55, 0x00020000
    buffer_load_dwordx4 v[8:11], v4, s[16:19], 0 offen
    v_mov_b32 v15, 0x3f803f80
    v_and_b32 v3, 15, v2
    v_lshrrev_b32 v13, 4, v2
    s_waitcnt vmcnt(0)
    v_dot2_f32_bf16 v12, v8, v15, 0
    v_dot2_f32_bf16 v12, v9, v15, v12
    v_dot2_f32_bf16 v12, v10, v15, v12
    v_dot2_f32_bf16 v12, v11, v15, v12
    s_nop 2
    v_add_f32_dpp v12, v12, v12 row_ror:1 row_mask:0xf bank_mask:0xf
    s_nop 1
    v_add_f32_dpp v12, v12, v12 row_ror:2 row_mask:0xf bank_mask:0xf
    s_nop 1
    v_add_f32_dpp v12, v12, v12 row_ror:4 row_mask:0xf bank_mask:0xf
    s_nop 1
    v_add_f32_dpp v12, v12, v12 row_ror:8 row_mask:0xf bank_mask:0xf
    v_mov_b32 v14, v12
    s_nop 1
    v_permlane16_swap_b32 v12, v14
    v_add_f32 v12, v12, v14
    v_mov_b32 v14, v12
    s_nop 1
    v_permlane32_swap_b32 v12, v14
    v_add_f32 v12, v12, v14
    v_mov_b32 v109, 69632
    ds_write_b32 v109, v12 offset:48
    s_mul_i32 s56, s25, 11264
    s_add_u32 s56, s56, 75264
    s_lshl_b32 s27, s25, 8
    s_add_u32 s27, s27, 69696
    v_lshlrev_b32 v110, 4, v3
    v_add_u32 v111, 69696, v110
    v_add_u32 v110, s27, v110
    v_lshrrev_b32 v122, 1, v2
    v_lshlrev_b32 v122, 7, v122
    v_and_b32 v14, 1, v2
    v_lshl_add_u32 v122, v14, 4, v122
    v_add_u32 v122, 327680, v122
    v_lshrrev_b32 v8, 2, v3
    v_lshl_add_u32 v8, v13, 3, v8
    s_waitcnt lgkmcnt(0)
    s_cmp_eq_u32 s24, 2
    s_cbranch_scc1 K3_DOWN
    s_cmp_eq_u32 s24, 1
    s_cbranch_scc1 K3_FFN
    s_barrier
    s_barrier
    s_cmp_lg_u32 s25, 0
    s_cbranch_scc1 K3_P2IW
    s_mov_b32 s35, 400000
    s_mov_b32 s60, 0x7fff0000
    s_mov_b32 s61, 0x7fff0000
    v_lshlrev_b32 v124, 4, v2
    v_add_u32 v125, 262144, v124
    s_nop 4
K3_P2I:
    s_sleep 20
    buffer_load_dwordx4 v[112:115], v122, s[44:47], 0 offen sc1
    s_sub_u32 s35, s35, 1
    s_mov_b32 s62, s60
    s_mov_b32 s63, s61
    s_waitcnt vmcnt(0)
    v_max3_u32 v121, v112, v113, v114
    v_max_u32 v121, v121, v115
    v_cmp_eq_u32 s[64:65], -1, v121
    v_mov_b32 v6, 0xff7fffff
    s_nop 0
    v_cndmask_b32 v112, v112, v6, s[64:65]
    v_mov_b32 v5, v112
    s_nop 1
    v_mov_b32_dpp v7, v5 row_ror:1 row_mask:0xf bank_mask:0xf
    v_mov_b32_dpp v8, v6 row_ror:1 row_mask:0xf bank_mask:0xf
    v_min_f32 v9, v5, v7
    v_max_f32 v5, v5, v7
    v_max3_f32 v6, v6, v8, v9
    s_nop 0
    v_mov_b32_dpp v7, v5 row_ror:2 row_mask:0xf bank_mask:0xf
    v_mov_b32_dpp v8, v6 row_ror:2 row_mask:0xf bank_mask:0xf
    v_min_f32 v9, v5, v7
    v_max_f32 v5, v5, v7
    v_max3_f32 v6, v6, v8, v9
    s_nop 0
    v_mov_b32_dpp v7, v5 row_ror:4 row_mask:0xf bank_mask:0xf
    v_mov_b32_dpp v8, v6 row_ror:4 row_mask:0xf bank_mask:0xf
    v_min_f32 v9, v5, v7
    v_max_f32 v5, v5, v7
    v_max3_f32 v6, v6, v8, v9
    s_nop 0
    v_mov_b32_dpp v7, v5 row_ror:8 row_mask:0xf bank_mask:0xf
    v_mov_b32_dpp v8, v6 row_ror:8 row_mask:0xf bank_mask:0xf
    v_min_f32 v9, v5, v7
    v_max_f32 v5, v5, v7
    v_max3_f32 v6, v6, v8, v9
    v_mov_b32 v7, v5
    v_mov_b32 v8, v6
    s_nop 0
    v_permlane16_swap_b32 v5, v7
    v_permlane16_swap_b32 v6, v8
    v_min_f32 v9, v5, v7
    v_max_f32 v5, v5, v7
    v_max3_f32 v6, v6, v8, v9
    v_mov_b32 v7, v5
    v_mov_b32 v8, v6
    s_nop 0
    v_permlane32_swap_b32 v5, v7
    v_permlane32_swap_b32 v6, v8
    v_min_f32 v9, v5, v7
    v_max_f32 v5, v5, v7
    v_max3_f32 v6, v6, v8, v9
    v_cmp_eq_u32 vcc, v112, v5
    v_cmp_eq_u32 s[58:59], v112, v6
    s_ff1_i32_b64 s60, vcc
    s_ff1_i32_b64 s61, s[58:59]
    s_and_b32 s60, s60, 63
    s_and_b32 s61, s61, 63
    s_lshl_b32 s60, s60, 10
    s_lshl_b32 s61, s61, 10
    s_cmp_eq_u32 s35, 0
    s_cbranch_scc1 K3_P2IX
    s_cmp_lg_u64 s[64:65], 0
    s_cbranch_scc1 K3_P2I
K3_P2IX:
    v_cndmask_b32 v7, 0, 16, s[58:59]
    s_or_b64 exec, vcc, s[58:59]
    v_add_u32 v7, v7, v109
    ds_write_b128 v7, v[112:115] offset:1088
    s_mov_b64 exec, -1
    s_waitcnt lgkmcnt(0)
    s_nop 1
K3_P2IW:
    s_barrier
    s_endpgm
    s_nop 0
K3_FFN:
    v_mul_u32_u24 v4, 2752, v2
    v_add_u32 v4, s26, v4
    v_lshlrev_b32 v8, 4, v8
    v_and_b32 v9, 1, v3
    v_lshl_add_u32 v8, v9, 3, v8
    v_bfe_u32 v9, v3, 1, 1
    v_lshl_add_u32 v8, v9, 13, v8
    v_add_u32 v10, 75264, v8
    v_min_u32 v11, 3, v3
    v_lshlrev_b32 v11, 10, v11
    v_lshl_add_u32 v11, v13, 4, v11
    v_add_u32 v11, 71168, v11
    v_mov_b32 v13, v109
    v_lshlrev_b32 v1, 1, v3
    s_lshl_b32 s57, s26, 3
    s_add_u32 s57, s57, 724992
    v_lshlrev_b32 v14, 4, v2
    v_add_u32 v12, 262144, v14
    v_add_u32 v14, 71168, v14
    v_mov_b32 v16, v15
    v_mov_b32 v20, 0
    v_mov_b32 v17, v15
    v_mov_b32 v21, 0
    v_mov_b32 v18, v15
    v_mov_b32 v22, 0
    v_mov_b32 v19, v15
    v_mov_b32 v23, 0
    ds_write_b128 v14, v[16:19] offset:2048
    ds_write_b128 v14, v[20:23] offset:3072
    s_mov_b32 s34, 0
    s_mov_b32 m0, 75264
    s_nop 0
    buffer_load_dwordx4 v4, s[28:31], s34 offen lds
    s_mov_b32 m0, 83456
    s_nop 0
    buffer_load_dwordx4 v4, s[36:39], s34 offen lds
    s_mov_b32 s34, 176128
    s_mov_b32 m0, 76288
    s_nop 0
    buffer_load_dwordx4 v4, s[28:31], s34 offen lds
    s_mov_b32 m0, 84480
    s_nop 0
    buffer_load_dwordx4 v4, s[36:39], s34 offen lds
    s_mov_b32 s34, 352256
    s_mov_b32 m0, 77312
    s_nop 0
    buffer_load_dwordx4 v4, s[28:31], s34 offen lds
    s_mov_b32 m0, 85504
    s_nop 0
    buffer_load_dwordx4 v4, s[36:39], s34 offen lds
    s_mov_b32 s34, 528384
    s_mov_b32 m0, 78336
    s_nop 0
    buffer_load_dwordx4 v4, s[28:31], s34 offen lds
    s_mov_b32 m0, 86528
    s_nop 0
    buffer_load_dwordx4 v4, s[36:39], s34 offen lds
    s_mov_b32 s34, 704512
    s_mov_b32 m0, 79360
    s_nop 0
    buffer_load_dwordx4 v4, s[28:31], s34 offen lds
    s_mov_b32 m0, 87552
    s_nop 0
    buffer_load_dwordx4 v4, s[36:39], s34 offen lds
    s_mov_b32 s34, 880640
    s_mov_b32 m0, 80384
    s_nop 0
    buffer_load_dwordx4 v4, s[28:31], s34 offen lds
    s_mov_b32 m0, 88576
    s_nop 0
    buffer_load_dwordx4 v4, s[36:39], s34 offen lds
    s_mov_b32 s34, 1056768
    s_mov_b32 m0, 81408
    s_nop 0
    buffer_load_dwordx4 v4, s[28:31], s34 offen lds
    s_mov_b32 m0, 89600
    s_nop 0
    buffer_load_dwordx4 v4, s[36:39], s34 offen lds
    s_mov_b32 s34, 1232896
    s_mov_b32 m0, 82432
    s_nop 0
    buffer_load_dwordx4 v4, s[28:31], s34 offen lds
    s_mov_b32 m0, 90624
    s_nop 0
    buffer_load_dwordx4 v4, s[36:39], s34 offen lds
    s_waitcnt lgkmcnt(0)
    s_barrier
    s_barrier
    s_waitcnt vmcnt(0)
    ds_read_b64_tr_b16 v[16:17], v10 offset:0
    ds_read_b64_tr_b16 v[18:19], v10 offset:64
    ds_read_b64_tr_b16 v[20:21], v10 offset:512
    ds_read_b64_tr_b16 v[22:23], v10 offset:576
    ds_read_b64_tr_b16 v[24:25], v10 offset:1024
    ds_read_b64_tr_b16 v[26:27], v10 offset:1088
    ds_read_b64_tr_b16 v[28:29], v10 offset:1536
    ds_read_b64_tr_b16 v[30:31], v10 offset:1600
    ds_read_b64_tr_b16 v[32:33], v10 offset:2048
    ds_read_b64_tr_b16 v[34:35], v10 offset:2112
    ds_read_b64_tr_b16 v[36:37], v10 offset:2560
    ds_read_b64_tr_b16 v[38:39], v10 offset:2624
    ds_read_b64_tr_b16 v[40:41], v10 offset:3072
    ds_read_b64_tr_b16 v[42:43], v10 offset:3136
    ds_read_b64_tr_b16 v[44:45], v10 offset:3584
    ds_read_b64_tr_b16 v[46:47], v10 offset:3648
    ds_read_b64_tr_b16 v[48:49], v10 offset:4096
    ds_read_b64_tr_b16 v[50:51], v10 offset:4160
    ds_read_b64_tr_b16 v[52:53], v10 offset:4608
    ds_read_b64_tr_b16 v[54:55], v10 offset:4672
    ds_read_b64_tr_b16 v[56:57], v10 offset:5120
    ds_read_b64_tr_b16 v[58:59], v10 offset:5184
    ds_read_b64_tr_b16 v[60:61], v10 offset:5632
    ds_read_b64_tr_b16 v[62:63], v10 offset:5696
    ds_read_b64_tr_b16 v[64:65], v10 offset:6144
    ds_read_b64_tr_b16 v[66:67], v10 offset:6208
    ds_read_b64_tr_b16 v[68:69], v10 offset:6656
    ds_read_b64_tr_b16 v[70:71], v10 offset:6720
    ds_read_b64_tr_b16 v[72:73], v10 offset:7168
    ds_read_b64_tr_b16 v[74:75], v10 offset:7232
    ds_read_b64_tr_b16 v[76:77], v10 offset:7680
    ds_read_b64_tr_b16 v[78:79], v10 offset:7744
    s_mov_b32 s35, 400000
    s_mov_b32 s60, 0x7fff0000
    s_mov_b32 s61, 0x7fff0000
    s_sleep 24
    s_nop 0
K3_PF:
    buffer_load_dwordx4 v[144:147], v122, s[44:47], 0 offen sc1
    buffer_load_dwordx4 v[148:151], v12, s[44:47], s60 offen sc1
    buffer_load_dwordx4 v[152:155], v12, s[44:47], s61 offen sc1
    s_mov_b32 s68, s60
    s_mov_b32 s69, s61
    s_waitcnt vmcnt(2)
    v_max3_u32 v121, v144, v145, v146
    v_max_u32 v121, v121, v147
    v_cmp_eq_u32 s[64:65], -1, v121
    v_mov_b32 v6, 0xff7fffff
    s_nop 0
    v_cndmask_b32 v144, v144, v6, s[64:65]
    v_mov_b32 v5, v144
    s_nop 1
    v_mov_b32_dpp v7, v5 row_ror:1 row_mask:0xf bank_mask:0xf
    v_mov_b32_dpp v8, v6 row_ror:1 row_mask:0xf bank_mask:0xf
    v_min_f32 v9, v5, v7
    v_max_f32 v5, v5, v7
    v_max3_f32 v6, v6, v8, v9
    s_nop 0
    v_mov_b32_dpp v7, v5 row_ror:2 row_mask:0xf bank_mask:0xf
    v_mov_b32_dpp v8, v6 row_ror:2 row_mask:0xf bank_mask:0xf
    v_min_f32 v9, v5, v7
    v_max_f32 v5, v5, v7
    v_max3_f32 v6, v6, v8, v9
    s_nop 0
    v_mov_b32_dpp v7, v5 row_ror:4 row_mask:0xf bank_mask:0xf
    v_mov_b32_dpp v8, v6 row_ror:4 row_mask:0xf bank_mask:0xf
    v_min_f32 v9, v5, v7
    v_max_f32 v5, v5, v7
    v_max3_f32 v6, v6, v8, v9
    s_nop 0
    v_mov_b32_dpp v7, v5 row_ror:8 row_mask:0xf bank_mask:0xf
    v_mov_b32_dpp v8, v6 row_ror:8 row_mask:0xf bank_mask:0xf
    v_min_f32 v9, v5, v7
    v_max_f32 v5, v5, v7
    v_max3_f32 v6, v6, v8, v9
    v_mov_b32 v7, v5
    v_mov_b32 v8, v6
    s_nop 0
    v_permlane16_swap_b32 v5, v7
    v_permlane16_swap_b32 v6, v8
    v_min_f32 v9, v5, v7
    v_max_f32 v5, v5, v7
    v_max3_f32 v6, v6, v8, v9
    v_mov_b32 v7, v5
    v_mov_b32 v8, v6
    s_nop 0
    v_permlane32_swap_b32 v5, v7
    v_permlane32_swap_b32 v6, v8
    v_min_f32 v9, v5, v7
    v_max_f32 v5, v5, v7
    v_max3_f32 v6, v6, v8, v9
    v_cmp_eq_u32 vcc, v144, v5
    v_cmp_eq_u32 s[58:59], v144, v6
    s_ff1_i32_b64 s60, vcc
    s_ff1_i32_b64 s61, s[58:59]
    s_and_b32 s60, s60, 63
    s_and_b32 s61, s61, 63
    s_lshl_b32 s60, s60, 10
    s_lshl_b32 s61, s61, 10
    s_xor_b32 s62, s68, s60
    s_xor_b32 s63, s69, s61
    s_or_b32 s62, s62, s63
    s_cmp_eq_u32 s62, 0
    s_cbranch_scc1 K3_PFR1
    s_cmp_lg_u64 s[64:65], 0
    s_cbranch_scc1 K3_PFR1
    buffer_load_dwordx4 v[148:151], v12, s[44:47], s60 offen sc1
    buffer_load_dwordx4 v[152:155], v12, s[44:47], s61 offen sc1
    s_mov_b32 s68, s60
    s_mov_b32 s69, s61
K3_PFR1:
    s_waitcnt vmcnt(0)
    v_max3_u32 v121, v148, v149, v150
    v_max3_u32 v121, v121, v151, v152
    v_max3_u32 v121, v121, v153, v154
    v_max_u32 v121, v121, v155
    v_cmp_eq_u32 s[66:67], -1, v121
    s_nop 0
    s_or_b64 s[64:65], s[64:65], s[66:67]
    s_xor_b32 s62, s68, s60
    s_xor_b32 s63, s69, s61
    s_or_b32 s62, s62, s63
    s_or_b32 s64, s64, s62
    s_cmp_eq_u64 s[64:65], 0
    s_cbranch_scc1 K3_PFD0
    s_sub_u32 s35, s35, 1
    s_cmp_lg_u32 s35, 0
    s_cbranch_scc1 K3_PF
K3_PFD0:
    ds_write_b128 v14, v[148:151]
    ds_write_b128 v14, v[152:155] offset:1024
    v_cndmask_b32 v7, 0, 16, s[58:59]
    s_or_b64 exec, vcc, s[58:59]
    v_add_u32 v7, v7, v13
    ds_write_b128 v7, v[144:147] offset:1088
    s_mov_b64 exec, -1
    s_nop 2
K3_PFJ:
    ds_read_b128 v[80:83], v11 offset:0
    ds_read_b128 v[84:87], v11 offset:64
    ds_read_b128 v[88:91], v11 offset:128
    ds_read_b128 v[92:95], v11 offset:192
    ds_read_b128 v[96:99], v11 offset:256
    ds_read_b128 v[100:103], v11 offset:320
    ds_read_b128 v[104:107], v11 offset:384
    ds_read_b128 v[108:111], v11 offset:448
    ds_read_b128 v[112:115], v11 offset:512
    ds_read_b128 v[116:119], v11 offset:576
    ds_read_b128 v[120:123], v11 offset:640
    ds_read_b128 v[124:127], v11 offset:704
    s_waitcnt lgkmcnt(8)
    v_mfma_f32_16x16x32_bf16 v[180:183], v[80:83], v[16:19], 0
    v_mfma_f32_16x16x32_bf16 v[180:183], v[84:87], v[20:23], v[180:183]
    v_mfma_f32_16x16x32_bf16 v[180:183], v[88:91], v[24:27], v[180:183]
    v_mfma_f32_16x16x32_bf16 v[180:183], v[92:95], v[28:31], v[180:183]
    ds_read_b128 v[128:131], v11 offset:768
    ds_read_b128 v[132:135], v11 offset:832
    ds_read_b128 v[136:139], v11 offset:896
    ds_read_b128 v[140:143], v11 offset:960
    ds_read_b128 v[184:187], v13 offset:1088
    ds_read_b128 v[188:191], v13 offset:1104
    s_barrier
    s_waitcnt lgkmcnt(10)
    v_mfma_f32_16x16x32_bf16 v[180:183], v[96:99], v[32:35], v[180:183]
    v_mfma_f32_16x16x32_bf16 v[180:183], v[100:103], v[36:39], v[180:183]
    v_mfma_f32_16x16x32_bf16 v[180:183], v[104:107], v[40:43], v[180:183]
    v_mfma_f32_16x16x32_bf16 v[180:183], v[108:111], v[44:47], v[180:183]
    s_waitcnt lgkmcnt(6)
    v_mfma_f32_16x16x32_bf16 v[180:183], v[112:115], v[48:51], v[180:183]
    v_mfma_f32_16x16x32_bf16 v[180:183], v[116:119], v[52:55], v[180:183]
    v_mfma_f32_16x16x32_bf16 v[180:183], v[120:123], v[56:59], v[180:183]
    v_mfma_f32_16x16x32_bf16 v[180:183], v[124:127], v[60:63], v[180:183]
    s_waitcnt lgkmcnt(2)
    v_mfma_f32_16x16x32_bf16 v[180:183], v[128:131], v[64:67], v[180:183]
    v_mfma_f32_16x16x32_bf16 v[180:183], v[132:135], v[68:71], v[180:183]
    v_mfma_f32_16x16x32_bf16 v[180:183], v[136:139], v[72:75], v[180:183]
    v_mfma_f32_16x16x32_bf16 v[180:183], v[140:143], v[76:79], v[180:183]
    s_waitcnt lgkmcnt(0)
    s_nop 6
    v_mov_b32 v44, v180
    v_mov_b32 v45, v181
    v_mov_b32 v46, v182
    v_fma_f32 v44, -v185, v46, v44
    v_fma_f32 v45, -v189, v46, v45
    v_mul_f32 v44, v186, v44
    v_mul_f32 v45, v190, v45
    v_mul_f32 v48, 0xbfb8aa3b, v44
    v_mul_f32 v49, 0xbfb8aa3b, v45
    v_exp_f32 v48, v48
    v_exp_f32 v49, v49
    v_mul_f32_dpp v50, v44, v44 row_ror:8 row_mask:0xf bank_mask:0xf
    v_mul_f32_dpp v51, v45, v45 row_ror:8 row_mask:0xf bank_mask:0xf
    v_add_f32 v48, 1.0, v48
    v_add_f32 v49, 1.0, v49
    v_rcp_f32 v48, v48
    v_rcp_f32 v49, v49
    v_mul_f32 v50, v50, v48
    v_mul_f32 v51, v51, v49
    s_nop 0
    v_mov_b32_dpp v52, v50 quad_perm:[1,0,3,2] row_mask:0xf bank_mask:0xf
    v_mov_b32_dpp v53, v51 quad_perm:[1,0,3,2] row_mask:0xf bank_mask:0xf
    v_cvt_pk_bf16_f32 v50, v50, v52
    v_cvt_pk_bf16_f32 v51, v51, v53
    v_min_u32 v50, -2, v50
    v_min_u32 v51, -2, v51
    v_mov_b32 v56, v50
    v_mov_b32_dpp v57, v50 row_shl:2 row_mask:0xf bank_mask:0xf
    v_mov_b32_dpp v58, v50 row_shl:4 row_mask:0xf bank_mask:0xf
    v_mov_b32_dpp v59, v50 row_shl:6 row_mask:0xf bank_mask:0xf
    v_mov_b32 v60, v51
    v_mov_b32_dpp v61, v51 row_shl:2 row_mask:0xf bank_mask:0xf
    v_mov_b32_dpp v62, v51 row_shl:4 row_mask:0xf bank_mask:0xf
    v_mov_b32_dpp v63, v51 row_shl:6 row_mask:0xf bank_mask:0xf
    s_mov_b64 exec, 1
    buffer_store_dwordx4 v[56:59], v1, s[44:47], s57 offen sc1
    buffer_store_dwordx4 v[60:63], v1, s[44:47], s57 offen offset:16 sc1
    s_endpgm
    s_nop 0
K3_DOWN:
    v_mov_b32 v64, 0
    v_mov_b32 v128, 0
    v_mov_b32 v65, 0
    v_mov_b32 v129, 0
    v_mov_b32 v66, 0
    v_mov_b32 v130, 0
    v_mov_b32 v67, 0
    v_mov_b32 v131, 0
    v_mov_b32 v68, 0
    v_mov_b32 v132, 0
    v_mov_b32 v69, 0
    v_mov_b32 v133, 0
    v_mov_b32 v70, 0
    v_mov_b32 v134, 0
    v_mov_b32 v71, 0
    v_mov_b32 v135, 0
    v_mov_b32 v72, 0
    v_mov_b32 v136, 0
    v_mov_b32 v73, 0
    v_mov_b32 v137, 0
    v_mov_b32 v74, 0
    v_mov_b32 v138, 0
    v_mov_b32 v75, 0
    v_mov_b32 v139, 0
    v_mov_b32 v76, 0
    v_mov_b32 v140, 0
    v_mov_b32 v77, 0
    v_mov_b32 v141, 0
    v_mov_b32 v78, 0
    v_mov_b32 v142, 0
    v_mov_b32 v79, 0
    v_mov_b32 v143, 0
    v_mov_b32 v80, 0
    v_mov_b32 v144, 0
    v_mov_b32 v81, 0
    v_mov_b32 v145, 0
    v_mov_b32 v82, 0
    v_mov_b32 v146, 0
    v_mov_b32 v83, 0
    v_mov_b32 v147, 0
    v_mov_b32 v84, 0
    v_mov_b32 v148, 0
    v_mov_b32 v85, 0
    v_mov_b32 v149, 0
    v_mov_b32 v86, 0
    v_mov_b32 v150, 0
    v_mov_b32 v87, 0
    v_mov_b32 v151, 0
    v_mov_b32 v88, 0
    v_mov_b32 v152, 0
    v_mov_b32 v89, 0
    v_mov_b32 v153, 0
    v_mov_b32 v90, 0
    v_mov_b32 v154, 0
    v_mov_b32 v91, 0
    v_mov_b32 v155, 0
    v_mov_b32 v92, 0
    v_mov_b32 v156, 0
    v_mov_b32 v93, 0
    v_mov_b32 v157, 0
    v_mov_b32 v94, 0
    v_mov_b32 v158, 0
    v_mov_b32 v95, 0
    v_mov_b32 v159, 0
    v_mov_b32 v96, 0
    v_mov_b32 v160, 0
    v_mov_b32 v97, 0
    v_mov_b32 v161, 0
    v_mov_b32 v98, 0
    v_mov_b32 v162, 0
    v_mov_b32 v99, 0
    v_mov_b32 v163, 0
    v_mov_b32 v100, 0
    v_mov_b32 v164, 0
    v_mov_b32 v101, 0
    v_mov_b32 v165, 0
    v_mov_b32 v102, 0
    v_mov_b32 v166, 0
    v_mov_b32 v103, 0
    v_mov_b32 v167, 0
    v_mov_b32 v104, 0
    v_mov_b32 v168, 0
    v_mov_b32 v105, 0
    v_mov_b32 v169, 0
    v_mov_b32 v106, 0
    v_mov_b32 v170, 0
    v_mov_b32 v107, 0
    v_mov_b32 v171, 0
    v_lshrrev_b32 v4, 1, v2
    v_lshlrev_b32 v4, 10, v4
    v_lshl_add_u32 v4, v14, 4, v4
    s_lshl_b32 s27, s25, 15
    s_add_u32 s27, s27, s26
    v_add_u32 v4, s27, v4
    v_lshlrev_b32 v8, 5, v8
    v_and_b32 v9, 3, v3
    v_lshl_add_u32 v8, v9, 3, v8
    v_add_u32 v10, s56, v8
    v_lshlrev_b32 v11, 7, v13
    v_lshl_add_u32 v11, v3, 4, v11
    s_lshl_b32 s27, s25, 9
    s_add_u32 s27, s27, 724992
    v_add_u32 v11, s27, v11
    v_bfe_u32 v14, v2, 4, 1
    v_lshl_add_u32 v111, v14, 2, v111
    s_mov_b32 s48, 4096
    s_mov_b32 s49, 8192
    s_mov_b32 s50, 12288
    s_mov_b32 s51, 16384
    s_mov_b32 s57, 20480
    s_barrier
    s_add_u32 m0, s56, 0
    s_mov_b32 s34, 0
    buffer_load_dwordx4 v4, s[40:43], s34 offen lds
    s_add_u32 m0, s56, 1024
    s_mov_b32 s34, 131072
    buffer_load_dwordx4 v4, s[40:43], s34 offen lds
    s_add_u32 m0, s56, 2048
    s_mov_b32 s34, 262144
    buffer_load_dwordx4 v4, s[40:43], s34 offen lds
    s_add_u32 m0, s56, 3072
    s_mov_b32 s34, 393216
    buffer_load_dwordx4 v4, s[40:43], s34 offen lds
    s_add_u32 m0, s56, 4096
    s_mov_b32 s34, 524288
    buffer_load_dwordx4 v4, s[40:43], s34 offen lds
    s_add_u32 m0, s56, 5120
    s_mov_b32 s34, 655360
    buffer_load_dwordx4 v4, s[40:43], s34 offen lds
    s_add_u32 m0, s56, 6144
    s_mov_b32 s34, 786432
    buffer_load_dwordx4 v4, s[40:43], s34 offen lds
    s_add_u32 m0, s56, 7168
    s_mov_b32 s34, 917504
    buffer_load_dwordx4 v4, s[40:43], s34 offen lds
    s_add_u32 m0, s56, 8192
    s_mov_b32 s34, 1048576
    buffer_load_dwordx4 v4, s[40:43], s34 offen lds
    s_add_u32 m0, s56, 9216
    s_mov_b32 s34, 1179648
    buffer_load_dwordx4 v4, s[40:43], s34 offen lds
    s_add_u32 m0, s56, 10240
    s_mov_b32 s34, 1310720
    buffer_load_dwordx4 v4, s[40:43], s34 offen lds
    s_barrier
    s_waitcnt vmcnt(0)
    ds_read_b64_tr_b16 v[16:17], v10 offset:0
    ds_read_b64_tr_b16 v[18:19], v10 offset:128
    ds_read_b64_tr_b16 v[20:21], v10 offset:1024
    ds_read_b64_tr_b16 v[22:23], v10 offset:1152
    ds_read_b64_tr_b16 v[24:25], v10 offset:2048
    ds_read_b64_tr_b16 v[26:27], v10 offset:2176
    ds_read_b64_tr_b16 v[28:29], v10 offset:3072
    ds_read_b64_tr_b16 v[30:31], v10 offset:3200
    ds_read_b64_tr_b16 v[32:33], v10 offset:4096
    ds_read_b64_tr_b16 v[34:35], v10 offset:4224
    ds_read_b64_tr_b16 v[36:37], v10 offset:5120
    ds_read_b64_tr_b16 v[38:39], v10 offset:5248
    ds_read_b64_tr_b16 v[40:41], v10 offset:6144
    ds_read_b64_tr_b16 v[42:43], v10 offset:6272
    ds_read_b64_tr_b16 v[44:45], v10 offset:7168
    ds_read_b64_tr_b16 v[46:47], v10 offset:7296
    ds_read_b64_tr_b16 v[48:49], v10 offset:8192
    ds_read_b64_tr_b16 v[50:51], v10 offset:8320
    ds_read_b64_tr_b16 v[52:53], v10 offset:9216
    ds_read_b64_tr_b16 v[54:55], v10 offset:9344
    ds_read_b64_tr_b16 v[56:57], v10 offset:10240
    ds_read_b64_tr_b16 v[58:59], v10 offset:10368
    v_lshl_add_u32 v120, v14, 4, v109
    v_lshlrev_b32 v123, 1, v3
    v_add_u32 v123, s26, v123
    v_lshl_add_u32 v108, v14, 10, v123
    v_add_u32 v108, 71168, v108
    s_cmp_lg_u32 s25, 0
    s_cbranch_scc1 K3_P2DW
    s_mov_b32 s35, 400000
    s_mov_b32 s60, 0x7fff0000
    s_mov_b32 s61, 0x7fff0000
    v_lshlrev_b32 v124, 4, v2
    v_add_u32 v125, 262144, v124
    s_nop 4
K3_P2D:
    s_sleep 20
    buffer_load_dwordx4 v[112:115], v122, s[44:47], 0 offen sc1
    buffer_load_dwordx4 v[96:99], v125, s[44:47], s60 offen sc1
    buffer_load_dwordx4 v[100:103], v125, s[44:47], s61 offen sc1
    s_sub_u32 s35, s35, 1
    s_mov_b32 s62, s60
    s_mov_b32 s63, s61
    s_waitcnt vmcnt(2)
    v_max3_u32 v121, v112, v113, v114
    v_max_u32 v121, v121, v115
    v_cmp_eq_u32 s[64:65], -1, v121
    v_mov_b32 v6, 0xff7fffff
    s_nop 0
    v_cndmask_b32 v112, v112, v6, s[64:65]
    v_mov_b32 v5, v112
    s_nop 1
    v_mov_b32_dpp v7, v5 row_ror:1 row_mask:0xf bank_mask:0xf
    v_mov_b32_dpp v8, v6 row_ror:1 row_mask:0xf bank_mask:0xf
    v_min_f32 v9, v5, v7
    v_max_f32 v5, v5, v7
    v_max3_f32 v6, v6, v8, v9
    s_nop 0
    v_mov_b32_dpp v7, v5 row_ror:2 row_mask:0xf bank_mask:0xf
    v_mov_b32_dpp v8, v6 row_ror:2 row_mask:0xf bank_mask:0xf
    v_min_f32 v9, v5, v7
    v_max_f32 v5, v5, v7
    v_max3_f32 v6, v6, v8, v9
    s_nop 0
    v_mov_b32_dpp v7, v5 row_ror:4 row_mask:0xf bank_mask:0xf
    v_mov_b32_dpp v8, v6 row_ror:4 row_mask:0xf bank_mask:0xf
    v_min_f32 v9, v5, v7
    v_max_f32 v5, v5, v7
    v_max3_f32 v6, v6, v8, v9
    s_nop 0
    v_mov_b32_dpp v7, v5 row_ror:8 row_mask:0xf bank_mask:0xf
    v_mov_b32_dpp v8, v6 row_ror:8 row_mask:0xf bank_mask:0xf
    v_min_f32 v9, v5, v7
    v_max_f32 v5, v5, v7
    v_max3_f32 v6, v6, v8, v9
    v_mov_b32 v7, v5
    v_mov_b32 v8, v6
    s_nop 0
    v_permlane16_swap_b32 v5, v7
    v_permlane16_swap_b32 v6, v8
    v_min_f32 v9, v5, v7
    v_max_f32 v5, v5, v7
    v_max3_f32 v6, v6, v8, v9
    v_mov_b32 v7, v5
    v_mov_b32 v8, v6
    s_nop 0
    v_permlane32_swap_b32 v5, v7
    v_permlane32_swap_b32 v6, v8
    v_min_f32 v9, v5, v7
    v_max_f32 v5, v5, v7
    v_max3_f32 v6, v6, v8, v9
    v_cmp_eq_u32 vcc, v112, v5
    v_cmp_eq_u32 s[58:59], v112, v6
    s_ff1_i32_b64 s60, vcc
    s_ff1_i32_b64 s61, s[58:59]
    s_and_b32 s60, s60, 63
    s_and_b32 s61, s61, 63
    s_lshl_b32 s60, s60, 10
    s_lshl_b32 s61, s61, 10
    s_waitcnt vmcnt(0)
    v_max3_u32 v121, v96, v97, v98
    v_max3_u32 v121, v121, v99, v100
    v_max3_u32 v121, v121, v101, v102
    v_max_u32 v121, v121, v103
    v_cmp_eq_u32 s[66:67], -1, v121
    s_nop 0
    s_or_b64 s[64:65], s[64:65], s[66:67]
    s_xor_b32 s62, s62, s60
    s_xor_b32 s63, s63, s61
    s_or_b32 s62, s62, s63
    s_or_b32 s64, s64, s62
    s_cmp_eq_u32 s35, 0
    s_cbranch_scc1 K3_P2DX
    s_cmp_lg_u64 s[64:65], 0
    s_cbranch_scc1 K3_P2D
K3_P2DX:
    v_add_u32 v124, 71168, v124
    ds_write_b128 v124, v[96:99]
    ds_write_b128 v124, v[100:103] offset:1024
    v_cndmask_b32 v7, 0, 16, s[58:59]
    s_or_b64 exec, vcc, s[58:59]
    v_add_u32 v7, v7, v109
    ds_write_b128 v7, v[112:115] offset:1088
    s_mov_b64 exec, -1
    s_waitcnt lgkmcnt(0)
    s_nop 1
K3_P2DW:
    s_barrier
    ds_read_b128 v[116:119], v120 offset:1088
    ds_read_u16 v120, v108
    v_mov_b32 v96, 0
    v_mov_b32 v97, 0
    v_mov_b32 v98, 0
    v_mov_b32 v99, 0
    v_mov_b32 v100, 0
    v_mov_b32 v101, 0
    v_mov_b32 v102, 0
    v_mov_b32 v103, 0
    s_waitcnt lgkmcnt(0)
    v_and_b32 v9, 0x7ff, v116
    v_lshl_add_u32 v123, v9, 10, v123
    v_lshlrev_b32 v120, 16, v120
    v_mul_f32 v119, 0xbfb8aa3b, v119
    v_exp_f32 v119, v119
    v_sub_f32 v9, v120, v117
    v_add_f32 v119, 1.0, v119
    v_rcp_f32 v119, v119
    v_fma_f32 v120, v9, v118, v120
    s_mov_b32 exec_lo, 0x00030003
    s_mov_b32 exec_hi, 0x00030003
    s_mov_b32 s35, 400000
    buffer_load_dwordx4 v[64:67], v11, s[44:47], 0 offen offset:0 sc1
    buffer_load_dwordx4 v[68:71], v11, s[44:47], 0 offen offset:2048 sc1
    buffer_load_dwordx4 v[72:75], v11, s[44:47], s48 offen offset:0 sc1
    buffer_load_dwordx4 v[76:79], v11, s[44:47], s48 offen offset:2048 sc1
    buffer_load_dwordx4 v[80:83], v11, s[44:47], s49 offen offset:0 sc1
    buffer_load_dwordx4 v[84:87], v11, s[44:47], s49 offen offset:2048 sc1
    buffer_load_dwordx4 v[88:91], v11, s[44:47], s50 offen offset:0 sc1
    buffer_load_dwordx4 v[92:95], v11, s[44:47], s50 offen offset:2048 sc1
    buffer_load_dwordx4 v[96:99], v11, s[44:47], s51 offen offset:0 sc1
    buffer_load_dwordx4 v[100:103], v11, s[44:47], s51 offen offset:2048 sc1
    buffer_load_dwordx4 v[104:107], v11, s[44:47], s57 offen offset:0 sc1
    s_sleep 3
    s_nop 0
K3_P4:
    s_sleep 3
    buffer_load_dwordx4 v[128:131], v11, s[44:47], 0 offen offset:0 sc1
    buffer_load_dwordx4 v[132:135], v11, s[44:47], 0 offen offset:2048 sc1
    buffer_load_dwordx4 v[136:139], v11, s[44:47], s48 offen offset:0 sc1
    buffer_load_dwordx4 v[140:143], v11, s[44:47], s48 offen offset:2048 sc1
    buffer_load_dwordx4 v[144:147], v11, s[44:47], s49 offen offset:0 sc1
    buffer_load_dwordx4 v[148:151], v11, s[44:47], s49 offen offset:2048 sc1
    buffer_load_dwordx4 v[152:155], v11, s[44:47], s50 offen offset:0 sc1
    buffer_load_dwordx4 v[156:159], v11, s[44:47], s50 offen offset:2048 sc1
    buffer_load_dwordx4 v[160:163], v11, s[44:47], s51 offen offset:0 sc1
    buffer_load_dwordx4 v[164:167], v11, s[44:47], s51 offen offset:2048 sc1
    buffer_load_dwordx4 v[168:171], v11, s[44:47], s57 offen offset:0 sc1
    s_waitcnt vmcnt(21)
    v_max3_u32 v121, v64, v65, v66
    v_max_u32 v121, v121, v67
    s_waitcnt vmcnt(20)
    v_max3_u32 v121, v121, v68, v69
    v_max3_u32 v121, v121, v70, v71
    s_waitcnt vmcnt(19)
    v_max3_u32 v121, v121, v72, v73
    v_max3_u32 v121, v121, v74, v75
    s_waitcnt vmcnt(18)
    v_max3_u32 v121, v121, v76, v77
    v_max3_u32 v121, v121, v78, v79
    s_waitcnt vmcnt(17)
    v_max3_u32 v121, v121, v80, v81
    v_max3_u32 v121, v121, v82, v83
    s_waitcnt vmcnt(16)
    v_max3_u32 v121, v121, v84, v85
    v_max3_u32 v121, v121, v86, v87
    s_waitcnt vmcnt(15)
    v_max3_u32 v121, v121, v88, v89
    v_max3_u32 v121, v121, v90, v91
    s_waitcnt vmcnt(14)
    v_max3_u32 v121, v121, v92, v93
    v_max3_u32 v121, v121, v94, v95
    s_waitcnt vmcnt(13)
    v_max3_u32 v121, v121, v96, v97
    v_max3_u32 v121, v121, v98, v99
    s_waitcnt vmcnt(12)
    v_max3_u32 v121, v121, v100, v101
    v_max3_u32 v121, v121, v102, v103
    s_waitcnt vmcnt(11)
    v_max3_u32 v121, v121, v104, v105
    v_max3_u32 v121, v121, v106, v107
    v_cmp_eq_u32 vcc, -1, v121
    s_nop 4
    s_cbranch_vccz K3_P4D0
    s_sleep 3
    buffer_load_dwordx4 v[64:67], v11, s[44:47], 0 offen offset:0 sc1
    buffer_load_dwordx4 v[68:71], v11, s[44:47], 0 offen offset:2048 sc1
    buffer_load_dwordx4 v[72:75], v11, s[44:47], s48 offen offset:0 sc1
    buffer_load_dwordx4 v[76:79], v11, s[44:47], s48 offen offset:2048 sc1
    buffer_load_dwordx4 v[80:83], v11, s[44:47], s49 offen offset:0 sc1
    buffer_load_dwordx4 v[84:87], v11, s[44:47], s49 offen offset:2048 sc1
    buffer_load_dwordx4 v[88:91], v11, s[44:47], s50 offen offset:0 sc1
    buffer_load_dwordx4 v[92:95], v11, s[44:47], s50 offen offset:2048 sc1
    buffer_load_dwordx4 v[96:99], v11, s[44:47], s51 offen offset:0 sc1
    buffer_load_dwordx4 v[100:103], v11, s[44:47], s51 offen offset:2048 sc1
    buffer_load_dwordx4 v[104:107], v11, s[44:47], s57 offen offset:0 sc1
    s_waitcnt vmcnt(21)
    v_max3_u32 v121, v128, v129, v130
    v_max_u32 v121, v121, v131
    s_waitcnt vmcnt(20)
    v_max3_u32 v121, v121, v132, v133
    v_max3_u32 v121, v121, v134, v135
    s_waitcnt vmcnt(19)
    v_max3_u32 v121, v121, v136, v137
    v_max3_u32 v121, v121, v138, v139
    s_waitcnt vmcnt(18)
    v_max3_u32 v121, v121, v140, v141
    v_max3_u32 v121, v121, v142, v143
    s_waitcnt vmcnt(17)
    v_max3_u32 v121, v121, v144, v145
    v_max3_u32 v121, v121, v146, v147
    s_waitcnt vmcnt(16)
    v_max3_u32 v121, v121, v148, v149
    v_max3_u32 v121, v121, v150, v151
    s_waitcnt vmcnt(15)
    v_max3_u32 v121, v121, v152, v153
    v_max3_u32 v121, v121, v154, v155
    s_waitcnt vmcnt(14)
    v_max3_u32 v121, v121, v156, v157
    v_max3_u32 v121, v121, v158, v159
    s_waitcnt vmcnt(13)
    v_max3_u32 v121, v121, v160, v161
    v_max3_u32 v121, v121, v162, v163
    s_waitcnt vmcnt(12)
    v_max3_u32 v121, v121, v164, v165
    v_max3_u32 v121, v121, v166, v167
    s_waitcnt vmcnt(11)
    v_max3_u32 v121, v121, v168, v169
    v_max3_u32 v121, v121, v170, v171
    v_cmp_eq_u32 vcc, -1, v121
    s_nop 4
    s_cbranch_vccz K3_P4D1
    s_sub_u32 s35, s35, 1
    s_cmp_lg_u32 s35, 0
    s_cbranch_scc1 K3_P4
K3_P4D1:
    s_mov_b64 exec, -1
    v_mfma_f32_16x16x32_bf16 v[60:63], v[128:131], v[16:19], 0
    v_mfma_f32_16x16x32_bf16 v[124:127], v[132:135], v[20:23], 0
    v_mfma_f32_16x16x32_bf16 v[60:63], v[136:139], v[24:27], v[60:63]
    v_mfma_f32_16x16x32_bf16 v[124:127], v[140:143], v[28:31], v[124:127]
    v_mfma_f32_16x16x32_bf16 v[60:63], v[144:147], v[32:35], v[60:63]
    v_mfma_f32_16x16x32_bf16 v[124:127], v[148:151], v[36:39], v[124:127]
    v_mfma_f32_16x16x32_bf16 v[60:63], v[152:155], v[40:43], v[60:63]
    v_mfma_f32_16x16x32_bf16 v[124:127], v[156:159], v[44:47], v[124:127]
    v_mfma_f32_16x16x32_bf16 v[60:63], v[160:163], v[48:51], v[60:63]
    v_mfma_f32_16x16x32_bf16 v[124:127], v[164:167], v[52:55], v[124:127]
    v_mfma_f32_16x16x32_bf16 v[60:63], v[168:171], v[56:59], v[60:63]
    s_branch K3_P4J
    s_nop 6
K3_P4D0:
    s_mov_b64 exec, -1
    v_mfma_f32_16x16x32_bf16 v[60:63], v[64:67], v[16:19], 0
    v_mfma_f32_16x16x32_bf16 v[124:127], v[68:71], v[20:23], 0
    v_mfma_f32_16x16x32_bf16 v[60:63], v[72:75], v[24:27], v[60:63]
    v_mfma_f32_16x16x32_bf16 v[124:127], v[76:79], v[28:31], v[124:127]
    v_mfma_f32_16x16x32_bf16 v[60:63], v[80:83], v[32:35], v[60:63]
    v_mfma_f32_16x16x32_bf16 v[124:127], v[84:87], v[36:39], v[124:127]
    v_mfma_f32_16x16x32_bf16 v[60:63], v[88:91], v[40:43], v[60:63]
    v_mfma_f32_16x16x32_bf16 v[124:127], v[92:95], v[44:47], v[124:127]
    v_mfma_f32_16x16x32_bf16 v[60:63], v[96:99], v[48:51], v[60:63]
    v_mfma_f32_16x16x32_bf16 v[124:127], v[100:103], v[52:55], v[124:127]
    v_mfma_f32_16x16x32_bf16 v[60:63], v[104:107], v[56:59], v[60:63]
K3_P4J:
    s_nop 7
    v_pk_add_f32 v[60:61], v[60:61], v[124:125]
    s_mov_b64 exec, 0xffff
    ds_write_b64 v110, v[60:61]
    s_mov_b64 exec, -1
    s_waitcnt lgkmcnt(0)
    s_barrier
    s_cmp_lg_u32 s25, 0
    s_cbranch_scc1 K3_END
    ds_read_b32 v32, v111 offset:0
    ds_read_b32 v33, v111 offset:256
    ds_read_b32 v34, v111 offset:512
    ds_read_b32 v35, v111 offset:768
    s_waitcnt lgkmcnt(0)
    v_add_f32 v32, v32, v33
    v_add_f32 v34, v34, v35
    v_add_f32 v32, v32, v34
    v_fma_f32 v120, v32, v119, v120
    v_cvt_pk_bf16_f32 v120, v120, v120
    s_mov_b32 exec_lo, -1
    s_mov_b32 exec_hi, 0
    buffer_store_short v120, v123, s[52:55], 0 offen
K3_END:
    s_endpgm

CODE_END:
.section .rodata,"a"
.p2align 6
.amdhsa_kernel k1_kernel
  .amdhsa_next_free_vgpr 240
  .amdhsa_next_free_sgpr 102
  .amdhsa_accum_offset 240
  .amdhsa_group_segment_fixed_size 0
  .amdhsa_kernarg_size 88
  .amdhsa_user_sgpr_count 2
  .amdhsa_user_sgpr_kernarg_segment_ptr 1
  .amdhsa_system_sgpr_workgroup_id_x 1
  .amdhsa_float_denorm_mode_32 3
.end_amdhsa_kernel
```
